```python
import torch

def _softmax(x, axis=-1):
    return torch.softmax(x, dim=axis)
def _gelu(x):
    return torch.nn.functional.gelu(x, approximate="tanh")
def _silu(x):
    return torch.nn.functional.silu(x)
def _sigmoid(x):
    return torch.sigmoid(x)
def _layernorm(x, axis=-1, eps=1e-5):
    m = x.mean(dim=axis, keepdim=True)
    v = x.var(dim=axis, keepdim=True, unbiased=False)
    return (x - m) / torch.sqrt(v + eps)
def _scatter_add(tgt, idx, src, axis=0):
    return tgt.clone().index_add_(axis, idx, src)
def _segment_sum(src, seg, n):
    out = torch.zeros((n,) + src.shape[1:], dtype=src.dtype)
    return out.index_add_(0, seg, src)
def _pad(x, pw):
    flat = tuple(v for pair in reversed(pw) for v in pair)
    return torch.nn.functional.pad(x, flat)

kernel_name = 'gated_mix__grouped_kv_mqa__ssm_conv_s4d__prompt'

def setup_inputs():

    _w = (lambda a: (lambda t: t.to(torch.bfloat16) if t.is_floating_point() else t)(torch.as_tensor(a)))
    def _A_setup():
        B, S, D, H = 1, 2048, 512, 32
        Dh = D // H
        return {
            "x": _w((lambda *s: torch.randn(*s, dtype=torch.bfloat16) * 0.05)(B, S, D)),
            "wq": _w((lambda *s: torch.randn(*s, dtype=torch.bfloat16) * 0.8)(D, H * Dh)),
            "wk": _w((lambda *s: torch.randn(*s, dtype=torch.bfloat16) * 0.8)(D, Dh)),
            "wv": _w((lambda *s: torch.randn(*s, dtype=torch.bfloat16) * 0.05)(D, Dh)),
            "wo": _w((lambda *s: torch.randn(*s, dtype=torch.bfloat16) * 0.05)(H * Dh, D)),
        }
    _A_in = _A_setup()

    def _B_setup():
        Bsz, L, D, N = 1, 2048, 512, 128
        return {
            "u": _w((lambda *s: torch.randn(*s, dtype=torch.bfloat16) * 0.05)(Bsz, L, D)),
            "log_A_real": _w((lambda *s: torch.randn(*s, dtype=torch.bfloat16) * 6.4)(D, N) * 0.5),
            "A_imag": _w((lambda *s: torch.randn(*s, dtype=torch.bfloat16) * 0.05)(D, N) * 3.14),
            "C_real": _w((lambda *s: torch.randn(*s, dtype=torch.bfloat16) * 0.05)(D, N) / N ** 0.5),
            "C_imag": _w((lambda *s: torch.randn(*s, dtype=torch.bfloat16) * 0.05)(D, N) / N ** 0.5),
            "log_dt": _w((lambda *s: torch.randn(*s, dtype=torch.bfloat16) * 0.05)(D) * 0.5 - 4.0),
            "D_skip": _w((lambda *s: torch.randn(*s, dtype=torch.bfloat16) * 0.05)(D)),
        }
    _B_in = _B_setup()

    return {
        "A_x": _A_in["x"],
        "A_wq": _A_in["wq"],
        "A_wk": _A_in["wk"],
        "A_wv": _A_in["wv"],
        "A_wo": _A_in["wo"],
        "B_u": _B_in["u"],
        "B_log_A_real": _B_in["log_A_real"],
        "B_A_imag": _B_in["A_imag"],
        "B_C_real": _B_in["C_real"],
        "B_C_imag": _B_in["C_imag"],
        "B_log_dt": _B_in["log_dt"],
        "B_D_skip": _B_in["D_skip"],
        "gate_w": _w((lambda *s: torch.randn(*s, dtype=torch.bfloat16) * 0.05)(512) * 16.0),
    }

def reference(A_x, A_wq, A_wk, A_wv, A_wo, B_u, B_log_A_real, B_A_imag, B_C_real, B_C_imag, B_log_dt, B_D_skip, gate_w):
    def _A_ref(x, wq, wk, wv, wo):
        B, S, D = x.shape
        H = 32
        Dh = D // H
        q = (lambda x, *d: x.permute(*d))((x @ wq).reshape(B, S, H, Dh), 0, 2, 1, 3)
        k = x @ wk
        v = x @ wv
        scores = torch.einsum("bhqd,bkd->bhqk", q, k) * (Dh ** -0.5)
        p = _softmax(scores, axis=-1)
        o = torch.einsum("bhqk,bkd->bhqd", p, v)
        return (lambda x, *d: x.permute(*d))(o, 0, 2, 1, 3).reshape(B, S, H * Dh) @ wo

    def _B_ref(u, log_A_real, A_imag, C_real, C_imag, log_dt, D_skip):
        L = u.shape[1]
        dt = torch.exp(log_dt)
        A = -torch.exp(log_A_real) + 1j * A_imag
        C = (C_real + 1j * C_imag) * dt[:, None]
        pos = (lambda x, dt: x.to(dt))(torch.arange(L), log_dt.dtype)
        P = torch.exp((A * dt[:, None])[:, :, None] * pos[None, None, :])
        K = 2.0 * torch.einsum("dn,dnl->dl", C, P).real
        L2 = 2 * L
        u_t = (lambda x, *d: x.permute(*d))(u, 0, 2, 1)
        Kf = (lambda x, *a, **k: torch.fft.rfft(x.float(), *a, **k))(K, L2)
        Uf = (lambda x, *a, **k: torch.fft.rfft(x.float(), *a, **k))(u_t, L2)
        y = (lambda x, *a, **k: torch.fft.irfft(x, *a, **k).to(torch.bfloat16))(Uf * Kf[None, :, :], L2)[:, :, :L]
        y = (lambda x, *d: x.permute(*d))(y, 0, 2, 1)
        return y + u * D_skip[None, None, :]

    x = A_x
    g = _sigmoid((x * gate_w).sum(-1, keepdims=True))
    a = _A_ref(x, A_wq, A_wk, A_wv, A_wo)
    b = _B_ref(x, B_log_A_real, B_A_imag, B_C_real, B_C_imag, B_log_dt, B_D_skip)
    return g * a + (1 - g) * b
```

```asm
; @launch grid=(256,1,1) block=(768,1,1) lds=163840
.amdgcn_target "amdgcn-amd-amdhsa--gfx950"
.text
.globl gated_mix__grouped_kv_mqa__ssm_conv_s4d__prompt_kernel
.p2align 8
.type gated_mix__grouped_kv_mqa__ssm_conv_s4d__prompt_kernel,@function
gated_mix__grouped_kv_mqa__ssm_conv_s4d__prompt_kernel:
    s_cmp_ge_u32 s2, 256
    s_cbranch_scc1 F_end
    s_load_dwordx8 s[36:43], s[0:1], 0
    s_load_dwordx8 s[44:51], s[0:1], 96
    s_load_dwordx2 s[52:53], s[0:1], 32
    s_load_dwordx8 s[56:63], s[0:1], 48
    s_load_dwordx4 s[64:67], s[0:1], 80
    v_and_b32 v1, 63, v0
    v_lshrrev_b32 v2, 6, v0
    v_mov_b32 v166, 131072
    v_readfirstlane_b32 s20, v2
    v_mov_b32 v167, 1
    v_lshlrev_b32 v2, 4, v1
    s_and_b32 s21, s2, 7
    s_lshl_b32 s21, s21, 2
    s_lshr_b32 s22, s2, 6
    s_add_u32 s21, s21, s22
    s_bfe_u32 s22, s2, 0x30003
    s_and_b32 s24, s20, 3
    s_cmp_ge_u32 s20, 8
    s_cbranch_scc1 F_help
    s_cmp_ge_u32 s20, 4
    s_cbranch_scc1 F_kgen
    s_setprio 3
    v_lshrrev_b32 v5, 4, v1
    v_mov_b32 v9, 0
    v_lshlrev_b32 v8, 2, v1
    v_add_u32 v8, 131072, v8
    s_cmp_lg_u32 s20, 0
    s_cbranch_scc1 M_noz
    ds_write_b32 v8, v9
M_noz:
    s_waitcnt lgkmcnt(0)
    s_barrier
    s_mov_b32 s16, s50
    s_mov_b32 s17, s51
    s_mov_b32 s18, 16777216
    s_mov_b32 s19, 0x00020000
    v_and_b32 v3, 15, v1
    v_lshrrev_b32 v4, 1, v3
    v_xor_b32 v4, v4, v5
    v_lshlrev_b32 v6, 7, v3
    v_bfe_u32 v7, v1, 2, 2
    v_lshl_add_u32 v8, v5, 3, v7
    v_lshlrev_b32 v8, 7, v8
    v_and_b32 v9, 1, v1
    v_lshl_add_u32 v8, v9, 3, v8
    v_and_b32 v7, 2, v7
    v_and_b32 v9, 1, v5
    v_lshl_add_u32 v7, v9, 2, v7
    v_bfe_u32 v9, v1, 1, 1
    s_lshl_b32 s28, s24, 1
    v_add_u32 v9, s28, v9
    v_xor_b32 v7, v7, v9
    v_lshl_add_u32 v8, v7, 4, v8
    v_add_u32 v8, 65536, v8
    s_add_u32 s28, s24, 0
    s_and_b32 s28, s28, 3
    s_lshl_b32 s31, s28, 12
    v_add_u32 v20, s31, v8
    s_and_b32 s31, s28, 1
    s_lshl_b32 s31, s31, 2
    v_xor_b32 v7, s31, v4
    v_lshl_add_u32 v16, v7, 4, v6
    s_lshr_b32 s31, s28, 1
    s_lshl_b32 s31, s31, 13
    v_add_u32 v16, s31, v16
    s_add_u32 s28, s24, 1
    s_and_b32 s28, s28, 3
    s_lshl_b32 s31, s28, 12
    v_add_u32 v21, s31, v8
    s_and_b32 s31, s28, 1
    s_lshl_b32 s31, s31, 2
    v_xor_b32 v7, s31, v4
    v_lshl_add_u32 v17, v7, 4, v6
    s_lshr_b32 s31, s28, 1
    s_lshl_b32 s31, s31, 13
    v_add_u32 v17, s31, v17
    s_add_u32 s28, s24, 2
    s_and_b32 s28, s28, 3
    s_lshl_b32 s31, s28, 12
    v_add_u32 v22, s31, v8
    s_and_b32 s31, s28, 1
    s_lshl_b32 s31, s31, 2
    v_xor_b32 v7, s31, v4
    v_lshl_add_u32 v18, v7, 4, v6
    s_lshr_b32 s31, s28, 1
    s_lshl_b32 s31, s31, 13
    v_add_u32 v18, s31, v18
    s_add_u32 s28, s24, 3
    s_and_b32 s28, s28, 3
    s_lshl_b32 s31, s28, 12
    v_add_u32 v23, s31, v8
    s_and_b32 s31, s28, 1
    s_lshl_b32 s31, s31, 2
    v_xor_b32 v7, s31, v4
    v_lshl_add_u32 v19, v7, 4, v6
    s_lshr_b32 s31, s28, 1
    s_lshl_b32 s31, s31, 13
    v_add_u32 v19, s31, v19
    s_lshl_b32 s28, s24, 6
    s_add_u32 s28, s28, 131328
    v_lshl_add_u32 v24, v5, 4, s28
    v_lshrrev_b32 v7, 5, v1
    v_lshlrev_b32 v7, 9, v7
    v_lshl_add_u32 v7, v3, 4, v7
    v_and_b32 v8, 1, v5
    v_lshl_add_u32 v7, v8, 3, v7
    s_lshl_b32 s27, s20, 10
    s_add_u32 s27, s27, 132352
    v_add_u32 v7, s27, v7
    s_lshl_b32 s27, s20, 7
    s_add_u32 s27, s27, 140544
    v_lshl_add_u32 v8, v3, 2, s27
    v_mov_b64 v[28:29], 0
    v_mov_b64 v[30:31], 0
    v_mov_b64 v[32:33], 0
    v_mov_b64 v[34:35], 0
    v_mov_b64 v[36:37], 0
    v_mov_b64 v[38:39], 0
    v_mov_b64 v[40:41], 0
    v_mov_b64 v[42:43], 0
    v_mov_b64 v[44:45], 0
    v_mov_b64 v[46:47], 0
    v_mov_b64 v[48:49], 0
    v_mov_b64 v[50:51], 0
    v_mov_b64 v[52:53], 0
    v_mov_b64 v[54:55], 0
    v_mov_b64 v[56:57], 0
    v_mov_b64 v[58:59], 0
    s_mov_b32 s35, 30000
SP_1:
    ds_read_b32 v164, v166 offset:0
    s_waitcnt lgkmcnt(0)
    v_readfirstlane_b32 s34, v164
    s_nop 0
    s_cmp_ge_u32 s34, 4
    s_cbranch_scc1 SD_2
    s_sleep 1
    s_sub_u32 s35, s35, 1
    s_cmp_lg_u32 s35, 0
    s_cbranch_scc1 SP_1
SD_2:
    s_mov_b32 s35, 30000
SP_3:
    ds_read_b32 v164, v166 offset:128
    s_waitcnt lgkmcnt(0)
    v_readfirstlane_b32 s34, v164
    s_nop 0
    s_cmp_ge_u32 s34, 4
    s_cbranch_scc1 SD_4
    s_sleep 1
    s_sub_u32 s35, s35, 1
    s_cmp_lg_u32 s35, 0
    s_cbranch_scc1 SP_3
SD_4:
    ds_read_b64_tr_b16 v[60:61], v20 offset:0
    ds_read_b64_tr_b16 v[62:63], v20 offset:512
    ds_read_b128 v[64:67], v16 offset:0
    ds_read_b128 v[68:71], v16 offset:2048
    ds_read_b128 v[72:75], v16 offset:4096
    ds_read_b128 v[76:79], v16 offset:6144
    ds_read_b128 v[140:143], v24 offset:0
    ds_read_b64_tr_b16 v[80:81], v21 offset:0
    ds_read_b64_tr_b16 v[82:83], v21 offset:512
    ds_read_b128 v[84:87], v17 offset:0
    ds_read_b128 v[88:91], v17 offset:2048
    ds_read_b128 v[92:95], v17 offset:4096
    ds_read_b128 v[96:99], v17 offset:6144
    ds_read_b64_tr_b16 v[100:101], v22 offset:0
    ds_read_b64_tr_b16 v[102:103], v22 offset:512
    ds_read_b128 v[104:107], v18 offset:0
    ds_read_b128 v[108:111], v18 offset:2048
    ds_read_b128 v[112:115], v18 offset:4096
    ds_read_b128 v[116:119], v18 offset:6144
    s_waitcnt lgkmcnt(12)
    v_mfma_f32_16x16x32_bf16 v[28:31], v[60:63], v[64:67], v[28:31]
    v_mfma_f32_16x16x32_bf16 v[32:35], v[60:63], v[68:71], v[32:35]
    v_mfma_f32_16x16x32_bf16 v[36:39], v[60:63], v[72:75], v[36:39]
    v_mfma_f32_16x16x32_bf16 v[40:43], v[60:63], v[76:79], v[40:43]
    v_mfma_f32_16x16x32_bf16 v[44:47], v[140:143], v[64:67], v[44:47]
    v_mfma_f32_16x16x32_bf16 v[48:51], v[140:143], v[68:71], v[48:51]
    v_mfma_f32_16x16x32_bf16 v[52:55], v[140:143], v[72:75], v[52:55]
    v_mfma_f32_16x16x32_bf16 v[56:59], v[140:143], v[76:79], v[56:59]
    ds_read_b64_tr_b16 v[120:121], v23 offset:0
    ds_read_b64_tr_b16 v[122:123], v23 offset:512
    ds_read_b128 v[124:127], v19 offset:0
    ds_read_b128 v[128:131], v19 offset:2048
    ds_read_b128 v[132:135], v19 offset:4096
    ds_read_b128 v[136:139], v19 offset:6144
    s_waitcnt lgkmcnt(12)
    v_mfma_f32_16x16x32_bf16 v[28:31], v[80:83], v[84:87], v[28:31]
    v_mfma_f32_16x16x32_bf16 v[32:35], v[80:83], v[88:91], v[32:35]
    v_mfma_f32_16x16x32_bf16 v[36:39], v[80:83], v[92:95], v[36:39]
    v_mfma_f32_16x16x32_bf16 v[40:43], v[80:83], v[96:99], v[40:43]
    s_waitcnt lgkmcnt(6)
    v_mfma_f32_16x16x32_bf16 v[28:31], v[100:103], v[104:107], v[28:31]
    v_mfma_f32_16x16x32_bf16 v[32:35], v[100:103], v[108:111], v[32:35]
    v_mfma_f32_16x16x32_bf16 v[36:39], v[100:103], v[112:115], v[36:39]
    v_mfma_f32_16x16x32_bf16 v[40:43], v[100:103], v[116:119], v[40:43]
    s_waitcnt lgkmcnt(0)
    v_mfma_f32_16x16x32_bf16 v[28:31], v[120:123], v[124:127], v[28:31]
    v_mfma_f32_16x16x32_bf16 v[32:35], v[120:123], v[128:131], v[32:35]
    v_mfma_f32_16x16x32_bf16 v[36:39], v[120:123], v[132:135], v[36:39]
    v_mfma_f32_16x16x32_bf16 v[40:43], v[120:123], v[136:139], v[40:43]
    s_mov_b32 s35, 30000
SP_5:
    ds_read_b32 v164, v166 offset:132
    s_waitcnt lgkmcnt(0)
    v_readfirstlane_b32 s34, v164
    s_nop 0
    s_cmp_ge_u32 s34, 4
    s_cbranch_scc1 SD_6
    s_sleep 1
    s_sub_u32 s35, s35, 1
    s_cmp_lg_u32 s35, 0
    s_cbranch_scc1 SP_5
SD_6:
    ds_read_b64_tr_b16 v[60:61], v20 offset:16384
    ds_read_b64_tr_b16 v[62:63], v20 offset:16896
    ds_read_b128 v[64:67], v16 offset:16384
    ds_read_b128 v[68:71], v16 offset:18432
    ds_read_b128 v[72:75], v16 offset:20480
    ds_read_b128 v[76:79], v16 offset:22528
    ds_read_b128 v[140:143], v24 offset:256
    ds_read_b64_tr_b16 v[80:81], v21 offset:16384
    ds_read_b64_tr_b16 v[82:83], v21 offset:16896
    ds_read_b128 v[84:87], v17 offset:16384
    ds_read_b128 v[88:91], v17 offset:18432
    ds_read_b128 v[92:95], v17 offset:20480
    ds_read_b128 v[96:99], v17 offset:22528
    ds_read_b64_tr_b16 v[100:101], v22 offset:16384
    ds_read_b64_tr_b16 v[102:103], v22 offset:16896
    ds_read_b128 v[104:107], v18 offset:16384
    ds_read_b128 v[108:111], v18 offset:18432
    ds_read_b128 v[112:115], v18 offset:20480
    ds_read_b128 v[116:119], v18 offset:22528
    s_waitcnt lgkmcnt(12)
    v_mfma_f32_16x16x32_bf16 v[28:31], v[60:63], v[64:67], v[28:31]
    v_mfma_f32_16x16x32_bf16 v[32:35], v[60:63], v[68:71], v[32:35]
    v_mfma_f32_16x16x32_bf16 v[36:39], v[60:63], v[72:75], v[36:39]
    v_mfma_f32_16x16x32_bf16 v[40:43], v[60:63], v[76:79], v[40:43]
    v_mfma_f32_16x16x32_bf16 v[44:47], v[140:143], v[64:67], v[44:47]
    v_mfma_f32_16x16x32_bf16 v[48:51], v[140:143], v[68:71], v[48:51]
    v_mfma_f32_16x16x32_bf16 v[52:55], v[140:143], v[72:75], v[52:55]
    v_mfma_f32_16x16x32_bf16 v[56:59], v[140:143], v[76:79], v[56:59]
    ds_read_b64_tr_b16 v[120:121], v23 offset:16384
    ds_read_b64_tr_b16 v[122:123], v23 offset:16896
    ds_read_b128 v[124:127], v19 offset:16384
    ds_read_b128 v[128:131], v19 offset:18432
    ds_read_b128 v[132:135], v19 offset:20480
    ds_read_b128 v[136:139], v19 offset:22528
    s_waitcnt lgkmcnt(12)
    v_mfma_f32_16x16x32_bf16 v[28:31], v[80:83], v[84:87], v[28:31]
    v_mfma_f32_16x16x32_bf16 v[32:35], v[80:83], v[88:91], v[32:35]
    v_mfma_f32_16x16x32_bf16 v[36:39], v[80:83], v[92:95], v[36:39]
    v_mfma_f32_16x16x32_bf16 v[40:43], v[80:83], v[96:99], v[40:43]
    s_waitcnt lgkmcnt(6)
    v_mfma_f32_16x16x32_bf16 v[28:31], v[100:103], v[104:107], v[28:31]
    v_mfma_f32_16x16x32_bf16 v[32:35], v[100:103], v[108:111], v[32:35]
    v_mfma_f32_16x16x32_bf16 v[36:39], v[100:103], v[112:115], v[36:39]
    v_mfma_f32_16x16x32_bf16 v[40:43], v[100:103], v[116:119], v[40:43]
    s_waitcnt lgkmcnt(0)
    v_mfma_f32_16x16x32_bf16 v[28:31], v[120:123], v[124:127], v[28:31]
    v_mfma_f32_16x16x32_bf16 v[32:35], v[120:123], v[128:131], v[32:35]
    v_mfma_f32_16x16x32_bf16 v[36:39], v[120:123], v[132:135], v[36:39]
    v_mfma_f32_16x16x32_bf16 v[40:43], v[120:123], v[136:139], v[40:43]
    s_mov_b32 s35, 30000
SP_7:
    ds_read_b32 v164, v166 offset:136
    s_waitcnt lgkmcnt(0)
    v_readfirstlane_b32 s34, v164
    s_nop 0
    s_cmp_ge_u32 s34, 4
    s_cbranch_scc1 SD_8
    s_sleep 1
    s_sub_u32 s35, s35, 1
    s_cmp_lg_u32 s35, 0
    s_cbranch_scc1 SP_7
SD_8:
    ds_read_b64_tr_b16 v[60:61], v20 offset:32768
    ds_read_b64_tr_b16 v[62:63], v20 offset:33280
    ds_read_b128 v[64:67], v16 offset:32768
    ds_read_b128 v[68:71], v16 offset:34816
    ds_read_b128 v[72:75], v16 offset:36864
    ds_read_b128 v[76:79], v16 offset:38912
    ds_read_b128 v[140:143], v24 offset:512
    ds_read_b64_tr_b16 v[80:81], v21 offset:32768
    ds_read_b64_tr_b16 v[82:83], v21 offset:33280
    ds_read_b128 v[84:87], v17 offset:32768
    ds_read_b128 v[88:91], v17 offset:34816
    ds_read_b128 v[92:95], v17 offset:36864
    ds_read_b128 v[96:99], v17 offset:38912
    ds_read_b64_tr_b16 v[100:101], v22 offset:32768
    ds_read_b64_tr_b16 v[102:103], v22 offset:33280
    ds_read_b128 v[104:107], v18 offset:32768
    ds_read_b128 v[108:111], v18 offset:34816
    ds_read_b128 v[112:115], v18 offset:36864
    ds_read_b128 v[116:119], v18 offset:38912
    s_waitcnt lgkmcnt(12)
    v_mfma_f32_16x16x32_bf16 v[28:31], v[60:63], v[64:67], v[28:31]
    v_mfma_f32_16x16x32_bf16 v[32:35], v[60:63], v[68:71], v[32:35]
    v_mfma_f32_16x16x32_bf16 v[36:39], v[60:63], v[72:75], v[36:39]
    v_mfma_f32_16x16x32_bf16 v[40:43], v[60:63], v[76:79], v[40:43]
    v_mfma_f32_16x16x32_bf16 v[44:47], v[140:143], v[64:67], v[44:47]
    v_mfma_f32_16x16x32_bf16 v[48:51], v[140:143], v[68:71], v[48:51]
    v_mfma_f32_16x16x32_bf16 v[52:55], v[140:143], v[72:75], v[52:55]
    v_mfma_f32_16x16x32_bf16 v[56:59], v[140:143], v[76:79], v[56:59]
    ds_read_b64_tr_b16 v[120:121], v23 offset:32768
    ds_read_b64_tr_b16 v[122:123], v23 offset:33280
    ds_read_b128 v[124:127], v19 offset:32768
    ds_read_b128 v[128:131], v19 offset:34816
    ds_read_b128 v[132:135], v19 offset:36864
    ds_read_b128 v[136:139], v19 offset:38912
    s_waitcnt lgkmcnt(12)
    v_mfma_f32_16x16x32_bf16 v[28:31], v[80:83], v[84:87], v[28:31]
    v_mfma_f32_16x16x32_bf16 v[32:35], v[80:83], v[88:91], v[32:35]
    v_mfma_f32_16x16x32_bf16 v[36:39], v[80:83], v[92:95], v[36:39]
    v_mfma_f32_16x16x32_bf16 v[40:43], v[80:83], v[96:99], v[40:43]
    s_waitcnt lgkmcnt(6)
    v_mfma_f32_16x16x32_bf16 v[28:31], v[100:103], v[104:107], v[28:31]
    v_mfma_f32_16x16x32_bf16 v[32:35], v[100:103], v[108:111], v[32:35]
    v_mfma_f32_16x16x32_bf16 v[36:39], v[100:103], v[112:115], v[36:39]
    v_mfma_f32_16x16x32_bf16 v[40:43], v[100:103], v[116:119], v[40:43]
    s_waitcnt lgkmcnt(0)
    v_mfma_f32_16x16x32_bf16 v[28:31], v[120:123], v[124:127], v[28:31]
    v_mfma_f32_16x16x32_bf16 v[32:35], v[120:123], v[128:131], v[32:35]
    v_mfma_f32_16x16x32_bf16 v[36:39], v[120:123], v[132:135], v[36:39]
    v_mfma_f32_16x16x32_bf16 v[40:43], v[120:123], v[136:139], v[40:43]
    s_mov_b32 s35, 30000
SP_9:
    ds_read_b32 v164, v166 offset:140
    s_waitcnt lgkmcnt(0)
    v_readfirstlane_b32 s34, v164
    s_nop 0
    s_cmp_ge_u32 s34, 4
    s_cbranch_scc1 SD_10
    s_sleep 1
    s_sub_u32 s35, s35, 1
    s_cmp_lg_u32 s35, 0
    s_cbranch_scc1 SP_9
SD_10:
    ds_read_b64_tr_b16 v[60:61], v20 offset:49152
    ds_read_b64_tr_b16 v[62:63], v20 offset:49664
    ds_read_b128 v[64:67], v16 offset:49152
    ds_read_b128 v[68:71], v16 offset:51200
    ds_read_b128 v[72:75], v16 offset:53248
    ds_read_b128 v[76:79], v16 offset:55296
    ds_read_b128 v[140:143], v24 offset:768
    ds_read_b64_tr_b16 v[80:81], v21 offset:49152
    ds_read_b64_tr_b16 v[82:83], v21 offset:49664
    ds_read_b128 v[84:87], v17 offset:49152
    ds_read_b128 v[88:91], v17 offset:51200
    ds_read_b128 v[92:95], v17 offset:53248
    ds_read_b128 v[96:99], v17 offset:55296
    ds_read_b64_tr_b16 v[100:101], v22 offset:49152
    ds_read_b64_tr_b16 v[102:103], v22 offset:49664
    ds_read_b128 v[104:107], v18 offset:49152
    ds_read_b128 v[108:111], v18 offset:51200
    ds_read_b128 v[112:115], v18 offset:53248
    ds_read_b128 v[116:119], v18 offset:55296
    s_waitcnt lgkmcnt(12)
    v_mfma_f32_16x16x32_bf16 v[28:31], v[60:63], v[64:67], v[28:31]
    v_mfma_f32_16x16x32_bf16 v[32:35], v[60:63], v[68:71], v[32:35]
    v_mfma_f32_16x16x32_bf16 v[36:39], v[60:63], v[72:75], v[36:39]
    v_mfma_f32_16x16x32_bf16 v[40:43], v[60:63], v[76:79], v[40:43]
    v_mfma_f32_16x16x32_bf16 v[44:47], v[140:143], v[64:67], v[44:47]
    v_mfma_f32_16x16x32_bf16 v[48:51], v[140:143], v[68:71], v[48:51]
    v_mfma_f32_16x16x32_bf16 v[52:55], v[140:143], v[72:75], v[52:55]
    v_mfma_f32_16x16x32_bf16 v[56:59], v[140:143], v[76:79], v[56:59]
    ds_read_b64_tr_b16 v[120:121], v23 offset:49152
    ds_read_b64_tr_b16 v[122:123], v23 offset:49664
    ds_read_b128 v[124:127], v19 offset:49152
    ds_read_b128 v[128:131], v19 offset:51200
    ds_read_b128 v[132:135], v19 offset:53248
    ds_read_b128 v[136:139], v19 offset:55296
    s_waitcnt lgkmcnt(12)
    v_mfma_f32_16x16x32_bf16 v[28:31], v[80:83], v[84:87], v[28:31]
    v_mfma_f32_16x16x32_bf16 v[32:35], v[80:83], v[88:91], v[32:35]
    v_mfma_f32_16x16x32_bf16 v[36:39], v[80:83], v[92:95], v[36:39]
    v_mfma_f32_16x16x32_bf16 v[40:43], v[80:83], v[96:99], v[40:43]
    s_waitcnt lgkmcnt(6)
    v_mfma_f32_16x16x32_bf16 v[28:31], v[100:103], v[104:107], v[28:31]
    v_mfma_f32_16x16x32_bf16 v[32:35], v[100:103], v[108:111], v[32:35]
    v_mfma_f32_16x16x32_bf16 v[36:39], v[100:103], v[112:115], v[36:39]
    v_mfma_f32_16x16x32_bf16 v[40:43], v[100:103], v[116:119], v[40:43]
    s_waitcnt lgkmcnt(0)
    v_mfma_f32_16x16x32_bf16 v[28:31], v[120:123], v[124:127], v[28:31]
    v_mfma_f32_16x16x32_bf16 v[32:35], v[120:123], v[128:131], v[32:35]
    v_mfma_f32_16x16x32_bf16 v[36:39], v[120:123], v[132:135], v[36:39]
    v_mfma_f32_16x16x32_bf16 v[40:43], v[120:123], v[136:139], v[40:43]
    s_mov_b32 s28, 0x3eb8aa3b
    ds_write_b32 v8, v44 offset:0
    ds_write_b32 v8, v48 offset:64
    ds_write_b32 v8, v52 offset:512
    ds_write_b32 v8, v56 offset:576
    v_mul_f32 v28, s28, v28
    v_mul_f32 v29, s28, v29
    v_mul_f32 v30, s28, v30
    v_mul_f32 v31, s28, v31
    v_mul_f32 v32, s28, v32
    v_mul_f32 v33, s28, v33
    v_mul_f32 v34, s28, v34
    v_mul_f32 v35, s28, v35
    v_mul_f32 v36, s28, v36
    v_mul_f32 v37, s28, v37
    v_mul_f32 v38, s28, v38
    v_mul_f32 v39, s28, v39
    v_mul_f32 v40, s28, v40
    v_mul_f32 v41, s28, v41
    v_mul_f32 v42, s28, v42
    v_mul_f32 v43, s28, v43
    v_cvt_pk_bf16_f32 v28, v28, v29
    v_cvt_pk_bf16_f32 v29, v30, v31
    v_cvt_pk_bf16_f32 v30, v32, v33
    v_cvt_pk_bf16_f32 v31, v34, v35
    v_cvt_pk_bf16_f32 v32, v36, v37
    v_cvt_pk_bf16_f32 v33, v38, v39
    v_cvt_pk_bf16_f32 v34, v40, v41
    v_cvt_pk_bf16_f32 v35, v42, v43
    ds_write_b64 v7, v[28:29] offset:0
    ds_write_b64 v7, v[30:31] offset:256
    ds_write_b64 v7, v[32:33] offset:4096
    ds_write_b64 v7, v[34:35] offset:4352
    s_mov_b64 exec, 1
    ds_add_u32 v166, v167 offset:4
    s_mov_b64 exec, -1
M_att:
    s_setprio 1
    s_lshr_b32 s23, s20, 2
    s_and_b32 s24, s20, 3
    v_and_b32 v3, 15, v1
    v_lshlrev_b32 v3, 4, v3
    v_lshrrev_b32 v4, 5, v1
    v_lshl_add_u32 v3, v4, 8, v3
    s_mov_b32 s32, 0x0000ffff
    s_mov_b32 s33, 0x0000ffff
    s_lshl_b32 s25, s24, 14
    s_add_u32 s26, s25, 65536
    s_add_u32 s25, s25, 0
    v_and_b32 v4, 27, v1
    v_cmp_eq_u32 vcc, 16, v4
    v_mov_b32 v4, 0
    v_mov_b32 v6, 0x3f803f80
    v_cndmask_b32 v4, v4, v6, vcc
    v_mov_b32 v160, 0xdddd
    v_mov_b32 v5, v4
    v_mov_b64 v[140:141], v[4:5]
    v_mov_b64 v[142:143], v[4:5]
    v_mov_b64 v[144:145], v[4:5]
    v_mov_b64 v[146:147], v[4:5]
    v_mov_b64 v[152:153], v[4:5]
    v_mov_b64 v[154:155], v[4:5]
    v_mov_b64 v[156:157], v[4:5]
    v_mov_b64 v[158:159], v[4:5]
    s_mov_b32 s35, 30000
SP_11:
    ds_read_b32 v164, v166 offset:16
    s_waitcnt lgkmcnt(0)
    v_readfirstlane_b32 s34, v164
    s_nop 0
    s_cmp_ge_u32 s34, 4
    s_cbranch_scc1 SD_12
    s_sleep 1
    s_sub_u32 s35, s35, 1
    s_cmp_lg_u32 s35, 0
    s_cbranch_scc1 SP_11
SD_12:
    buffer_load_dwordx4 v[136:139], v2, s[16:19], s25 offen sc1
    s_add_u32 s25, s25, 1024
    s_mov_b64 exec, s[32:33]
    buffer_load_dwordx4 v[140:143], v3, s[16:19], s26 offen sc1
    buffer_load_dwordx4 v[144:147], v3, s[16:19], s26 offen offset:512 sc1
    s_mov_b64 exec, -1
    s_add_u32 s26, s26, 1024
    buffer_load_dwordx4 v[148:151], v2, s[16:19], s25 offen sc1
    s_add_u32 s25, s25, 1024
    v_mov_b64 v[24:25], 0
    v_mov_b64 v[26:27], 0
    v_mov_b64 v[28:29], 0
    v_mov_b64 v[30:31], 0
    v_mov_b64 v[32:33], 0
    v_mov_b64 v[34:35], 0
    v_mov_b64 v[36:37], 0
    v_mov_b64 v[38:39], 0
    v_mov_b64 v[40:41], 0
    v_mov_b64 v[42:43], 0
    v_mov_b64 v[44:45], 0
    v_mov_b64 v[46:47], 0
    v_mov_b64 v[48:49], 0
    v_mov_b64 v[50:51], 0
    v_mov_b64 v[52:53], 0
    v_mov_b64 v[54:55], 0
    v_mov_b64 v[56:57], 0
    v_mov_b64 v[58:59], 0
    v_mov_b64 v[60:61], 0
    v_mov_b64 v[62:63], 0
    v_mov_b64 v[64:65], 0
    v_mov_b64 v[66:67], 0
    v_mov_b64 v[68:69], 0
    v_mov_b64 v[70:71], 0
    v_mov_b64 v[72:73], 0
    v_mov_b64 v[74:75], 0
    v_mov_b64 v[76:77], 0
    v_mov_b64 v[78:79], 0
    v_mov_b64 v[80:81], 0
    v_mov_b64 v[82:83], 0
    v_mov_b64 v[84:85], 0
    v_mov_b64 v[86:87], 0
    v_mov_b64 v[104:105], 0
    v_mov_b64 v[106:107], 0
    v_mov_b64 v[108:109], 0
    v_mov_b64 v[110:111], 0
    v_mov_b64 v[112:113], 0
    v_mov_b64 v[114:115], 0
    v_mov_b64 v[116:117], 0
    v_mov_b64 v[118:119], 0
    v_lshlrev_b32 v4, 2, v1
    s_lshl_b32 s27, s23, 6
    v_add_u32 v165, s27, v166
    s_add_u32 s28, s24, 1
    s_and_b32 s28, s28, 3
    s_lshl_b32 s31, s23, 2
    s_add_u32 s28, s28, s31
    s_mul_i32 s27, s28, 6912
    s_add_u32 s27, s27, 0
    v_add_u32 v120, s27, v2
    v_add_u32 v121, s27, v4
    s_lshl_b32 s28, s28, 10
    s_add_u32 s28, s28, 132352
    v_add_u32 v128, s28, v2
    s_add_u32 s28, s24, 2
    s_and_b32 s28, s28, 3
    s_lshl_b32 s31, s23, 2
    s_add_u32 s28, s28, s31
    s_mul_i32 s27, s28, 6912
    s_add_u32 s27, s27, 2304
    v_add_u32 v122, s27, v2
    v_add_u32 v123, s27, v4
    s_lshl_b32 s28, s28, 10
    s_add_u32 s28, s28, 132352
    v_add_u32 v129, s28, v2
    s_add_u32 s28, s24, 3
    s_and_b32 s28, s28, 3
    s_lshl_b32 s31, s23, 2
    s_add_u32 s28, s28, s31
    s_mul_i32 s27, s28, 6912
    s_add_u32 s27, s27, 4608
    v_add_u32 v124, s27, v2
    v_add_u32 v125, s27, v4
    s_lshl_b32 s28, s28, 10
    s_add_u32 s28, s28, 132352
    v_add_u32 v130, s28, v2
    s_add_u32 s28, s24, 4
    s_and_b32 s28, s28, 3
    s_lshl_b32 s31, s23, 2
    s_add_u32 s28, s28, s31
    s_mul_i32 s27, s28, 6912
    s_add_u32 s27, s27, 0
    v_add_u32 v126, s27, v2
    v_add_u32 v127, s27, v4
    s_lshl_b32 s28, s28, 10
    s_add_u32 s28, s28, 132352
    v_add_u32 v131, s28, v2
    s_mov_b32 s35, 30000
SP_13:
    ds_read_b32 v164, v166 offset:4
    s_waitcnt lgkmcnt(0)
    v_readfirstlane_b32 s34, v164
    s_nop 0
    s_cmp_ge_u32 s34, 4
    s_cbranch_scc1 SD_14
    s_sleep 1
    s_sub_u32 s35, s35, 1
    s_cmp_lg_u32 s35, 0
    s_cbranch_scc1 SP_13
SD_14:
    ds_read_b128 v[8:11], v128
    ds_read_b128 v[12:15], v129
    ds_read_b128 v[16:19], v130
    ds_read_b128 v[20:23], v131
    s_waitcnt vmcnt(3) lgkmcnt(0)
    v_mfma_f32_32x32x16_bf16 v[88:103], v[136:139], v[8:11], 0
    s_mov_b32 s28, 0
    s_add_u32 s30, s23, 7
    s_nop 7
    s_nop 2
    .p2align 6
M_loop:
    v_exp_f32 v88, v88
    v_exp_f32 v89, v89
    v_smfmac_f32_32x32x32_bf16 v[72:87], v[156:159], v[112:119], v160
    s_mov_b64 exec, s[32:33]
    buffer_load_dwordx4 v[152:155], v3, s[16:19], s26 offen sc1
    buffer_load_dwordx4 v[156:159], v3, s[16:19], s26 offen offset:512 sc1
    s_mov_b64 exec, -1
    s_add_u32 s26, s26, 1024
    v_exp_f32 v90, v90
    v_exp_f32 v91, v91
    v_exp_f32 v92, v92
    v_mfma_f32_32x32x16_bf16 v[104:119], v[136:139], v[12:15], 0
    v_exp_f32 v93, v93
    v_exp_f32 v94, v94
    v_exp_f32 v95, v95
    v_exp_f32 v96, v96
    v_exp_f32 v97, v97
    s_waitcnt vmcnt(3)
    v_smfmac_f32_32x32x32_bf16 v[24:39], v[140:143], v[88:95], v160
    v_exp_f32 v98, v98
    v_exp_f32 v99, v99
    v_exp_f32 v100, v100
    v_exp_f32 v101, v101
    v_exp_f32 v102, v102
    v_exp_f32 v103, v103
    v_exp_f32 v104, v104
    v_exp_f32 v105, v105
    v_smfmac_f32_32x32x32_bf16 v[24:39], v[144:147], v[96:103], v160
    v_exp_f32 v106, v106
    v_exp_f32 v107, v107
    v_exp_f32 v108, v108
    v_mfma_f32_32x32x16_bf16 v[88:103], v[136:139], v[16:19], 0
    v_exp_f32 v109, v109
    v_exp_f32 v110, v110
    v_exp_f32 v111, v111
    v_exp_f32 v112, v112
    v_exp_f32 v113, v113
    v_smfmac_f32_32x32x32_bf16 v[40:55], v[140:143], v[104:111], v160
    v_exp_f32 v114, v114
    v_exp_f32 v115, v115
    v_exp_f32 v116, v116
    v_exp_f32 v117, v117
    v_exp_f32 v118, v118
    v_exp_f32 v119, v119
    v_exp_f32 v88, v88
    v_exp_f32 v89, v89
    v_smfmac_f32_32x32x32_bf16 v[40:55], v[144:147], v[112:119], v160
    v_exp_f32 v90, v90
    v_exp_f32 v91, v91
    v_exp_f32 v92, v92
    v_mfma_f32_32x32x16_bf16 v[104:119], v[136:139], v[20:23], 0
    buffer_load_dwordx4 v[136:139], v2, s[16:19], s25 offen sc1
    s_add_u32 s25, s25, 1024
    v_exp_f32 v93, v93
    v_exp_f32 v94, v94
    v_exp_f32 v95, v95
    v_exp_f32 v96, v96
    v_exp_f32 v97, v97
    v_smfmac_f32_32x32x32_bf16 v[56:71], v[140:143], v[88:95], v160
    v_exp_f32 v98, v98
    v_exp_f32 v99, v99
    v_exp_f32 v100, v100
    v_exp_f32 v101, v101
    v_exp_f32 v102, v102
    v_exp_f32 v103, v103
    v_exp_f32 v104, v104
    v_exp_f32 v105, v105
    v_smfmac_f32_32x32x32_bf16 v[56:71], v[144:147], v[96:103], v160
    v_exp_f32 v106, v106
    v_exp_f32 v107, v107
    v_exp_f32 v108, v108
    s_waitcnt vmcnt(3)
    v_mfma_f32_32x32x16_bf16 v[88:103], v[148:151], v[8:11], 0
    v_exp_f32 v109, v109
    v_exp_f32 v110, v110
    v_exp_f32 v111, v111
    v_exp_f32 v112, v112
    v_exp_f32 v113, v113
    v_smfmac_f32_32x32x32_bf16 v[72:87], v[140:143], v[104:111], v160
    v_exp_f32 v114, v114
    v_exp_f32 v115, v115
    v_exp_f32 v116, v116
    v_exp_f32 v117, v117
    v_exp_f32 v118, v118
    v_exp_f32 v119, v119
    v_exp_f32 v88, v88
    v_exp_f32 v89, v89
    v_smfmac_f32_32x32x32_bf16 v[72:87], v[144:147], v[112:119], v160
    s_mov_b64 exec, s[32:33]
    buffer_load_dwordx4 v[140:143], v3, s[16:19], s26 offen sc1
    buffer_load_dwordx4 v[144:147], v3, s[16:19], s26 offen offset:512 sc1
    s_mov_b64 exec, -1
    s_add_u32 s26, s26, 1024
    v_exp_f32 v90, v90
    v_exp_f32 v91, v91
    v_exp_f32 v92, v92
    v_mfma_f32_32x32x16_bf16 v[104:119], v[148:151], v[12:15], 0
    v_exp_f32 v93, v93
    v_exp_f32 v94, v94
    v_exp_f32 v95, v95
    v_exp_f32 v96, v96
    v_exp_f32 v97, v97
    s_waitcnt vmcnt(3)
    v_smfmac_f32_32x32x32_bf16 v[24:39], v[152:155], v[88:95], v160
    v_exp_f32 v98, v98
    v_exp_f32 v99, v99
    v_exp_f32 v100, v100
    v_exp_f32 v101, v101
    v_exp_f32 v102, v102
    v_exp_f32 v103, v103
    v_exp_f32 v104, v104
    v_exp_f32 v105, v105
    v_smfmac_f32_32x32x32_bf16 v[24:39], v[156:159], v[96:103], v160
    v_exp_f32 v106, v106
    v_exp_f32 v107, v107
    v_exp_f32 v108, v108
    v_mfma_f32_32x32x16_bf16 v[88:103], v[148:151], v[16:19], 0
    v_exp_f32 v109, v109
    v_exp_f32 v110, v110
    v_exp_f32 v111, v111
    v_exp_f32 v112, v112
    v_exp_f32 v113, v113
    v_smfmac_f32_32x32x32_bf16 v[40:55], v[152:155], v[104:111], v160
    v_exp_f32 v114, v114
    v_exp_f32 v115, v115
    v_exp_f32 v116, v116
    v_exp_f32 v117, v117
    v_exp_f32 v118, v118
    v_exp_f32 v119, v119
    v_exp_f32 v88, v88
    v_exp_f32 v89, v89
    v_smfmac_f32_32x32x32_bf16 v[40:55], v[156:159], v[112:119], v160
    v_exp_f32 v90, v90
    v_exp_f32 v91, v91
    v_exp_f32 v92, v92
    v_mfma_f32_32x32x16_bf16 v[104:119], v[148:151], v[20:23], 0
    buffer_load_dwordx4 v[148:151], v2, s[16:19], s25 offen sc1
    s_add_u32 s25, s25, 1024
    v_exp_f32 v93, v93
    v_exp_f32 v94, v94
    v_exp_f32 v95, v95
    v_exp_f32 v96, v96
    v_exp_f32 v97, v97
    v_smfmac_f32_32x32x32_bf16 v[56:71], v[152:155], v[88:95], v160
    v_exp_f32 v98, v98
    v_exp_f32 v99, v99
    v_exp_f32 v100, v100
    v_exp_f32 v101, v101
    v_exp_f32 v102, v102
    v_exp_f32 v103, v103
    v_exp_f32 v104, v104
    v_exp_f32 v105, v105
    v_smfmac_f32_32x32x32_bf16 v[56:71], v[156:159], v[96:103], v160
    v_exp_f32 v106, v106
    v_exp_f32 v107, v107
    v_exp_f32 v108, v108
    s_waitcnt vmcnt(3)
    v_mfma_f32_32x32x16_bf16 v[88:103], v[136:139], v[8:11], 0
    v_exp_f32 v109, v109
    v_exp_f32 v110, v110
    v_exp_f32 v111, v111
    v_exp_f32 v112, v112
    v_exp_f32 v113, v113
    v_smfmac_f32_32x32x32_bf16 v[72:87], v[152:155], v[104:111], v160
    v_exp_f32 v114, v114
    v_exp_f32 v115, v115
    v_exp_f32 v116, v116
    v_exp_f32 v117, v117
    v_exp_f32 v118, v118
    v_exp_f32 v119, v119
    s_add_u32 s28, s28, 1
    s_cmp_lt_u32 s28, 7
    s_cbranch_scc1 M_loop
    s_cmp_lg_u32 s23, 0
    s_cbranch_scc1 M_last
    s_setprio 0
M_last:
    v_exp_f32 v88, v88
    v_exp_f32 v89, v89
    v_smfmac_f32_32x32x32_bf16 v[72:87], v[156:159], v[112:119], v160
    s_mov_b64 exec, s[32:33]
    buffer_load_dwordx4 v[152:155], v3, s[16:19], s26 offen sc1
    buffer_load_dwordx4 v[156:159], v3, s[16:19], s26 offen offset:512 sc1
    s_mov_b64 exec, -1
    s_add_u32 s26, s26, 1024
    v_exp_f32 v90, v90
    v_exp_f32 v91, v91
    v_exp_f32 v92, v92
    v_mfma_f32_32x32x16_bf16 v[104:119], v[136:139], v[12:15], 0
    v_exp_f32 v93, v93
    v_exp_f32 v94, v94
    v_exp_f32 v95, v95
    v_exp_f32 v96, v96
    v_exp_f32 v97, v97
    s_waitcnt vmcnt(3)
    v_smfmac_f32_32x32x32_bf16 v[24:39], v[140:143], v[88:95], v160
    v_exp_f32 v98, v98
    v_exp_f32 v99, v99
    v_exp_f32 v100, v100
    v_exp_f32 v101, v101
    v_exp_f32 v102, v102
    v_exp_f32 v103, v103
    v_exp_f32 v104, v104
    v_exp_f32 v105, v105
    v_smfmac_f32_32x32x32_bf16 v[24:39], v[144:147], v[96:103], v160
    v_exp_f32 v106, v106
    v_exp_f32 v107, v107
    v_exp_f32 v108, v108
    v_mfma_f32_32x32x16_bf16 v[88:103], v[136:139], v[16:19], 0
    v_exp_f32 v109, v109
    v_exp_f32 v110, v110
    v_exp_f32 v111, v111
    v_exp_f32 v112, v112
    v_exp_f32 v113, v113
    v_smfmac_f32_32x32x32_bf16 v[40:55], v[140:143], v[104:111], v160
    v_exp_f32 v114, v114
    v_exp_f32 v115, v115
    v_exp_f32 v116, v116
    v_exp_f32 v117, v117
    v_exp_f32 v118, v118
    v_exp_f32 v119, v119
    v_exp_f32 v88, v88
    v_exp_f32 v89, v89
    v_smfmac_f32_32x32x32_bf16 v[40:55], v[144:147], v[112:119], v160
    v_exp_f32 v90, v90
    v_exp_f32 v91, v91
    v_exp_f32 v92, v92
    v_mfma_f32_32x32x16_bf16 v[104:119], v[136:139], v[20:23], 0
    v_exp_f32 v93, v93
    v_exp_f32 v94, v94
    v_exp_f32 v95, v95
    v_exp_f32 v96, v96
    v_exp_f32 v97, v97
    v_smfmac_f32_32x32x32_bf16 v[56:71], v[140:143], v[88:95], v160
    v_exp_f32 v98, v98
    v_exp_f32 v99, v99
    v_exp_f32 v100, v100
    v_exp_f32 v101, v101
    v_exp_f32 v102, v102
    v_exp_f32 v103, v103
    v_exp_f32 v104, v104
    v_exp_f32 v105, v105
    v_smfmac_f32_32x32x32_bf16 v[56:71], v[144:147], v[96:103], v160
    v_exp_f32 v106, v106
    v_exp_f32 v107, v107
    v_exp_f32 v108, v108
    s_waitcnt vmcnt(2)
    v_mfma_f32_32x32x16_bf16 v[88:103], v[148:151], v[8:11], 0
    v_exp_f32 v109, v109
    v_exp_f32 v110, v110
    v_exp_f32 v111, v111
    v_exp_f32 v112, v112
    v_exp_f32 v113, v113
    v_smfmac_f32_32x32x32_bf16 v[72:87], v[140:143], v[104:111], v160
    v_exp_f32 v114, v114
    v_exp_f32 v115, v115
    v_exp_f32 v116, v116
    v_exp_f32 v117, v117
    v_exp_f32 v118, v118
    v_exp_f32 v119, v119
    v_exp_f32 v88, v88
    v_exp_f32 v89, v89
    v_smfmac_f32_32x32x32_bf16 v[72:87], v[144:147], v[112:119], v160
    v_exp_f32 v90, v90
    v_exp_f32 v91, v91
    v_exp_f32 v92, v92
    v_mfma_f32_32x32x16_bf16 v[104:119], v[148:151], v[12:15], 0
    v_exp_f32 v93, v93
    v_exp_f32 v94, v94
    v_exp_f32 v95, v95
    v_exp_f32 v96, v96
    v_exp_f32 v97, v97
    s_waitcnt vmcnt(0)
    v_smfmac_f32_32x32x32_bf16 v[24:39], v[152:155], v[88:95], v160
    ds_read_b32 v164, v166 offset:44
    v_exp_f32 v98, v98
    v_exp_f32 v99, v99
    v_exp_f32 v100, v100
    v_exp_f32 v101, v101
    v_exp_f32 v102, v102
    v_exp_f32 v103, v103
    v_exp_f32 v104, v104
    v_exp_f32 v105, v105
    v_smfmac_f32_32x32x32_bf16 v[24:39], v[156:159], v[96:103], v160
    v_exp_f32 v106, v106
    v_exp_f32 v107, v107
    v_exp_f32 v108, v108
    v_mfma_f32_32x32x16_bf16 v[88:103], v[148:151], v[16:19], 0
    v_exp_f32 v109, v109
    v_exp_f32 v110, v110
    v_exp_f32 v111, v111
    v_exp_f32 v112, v112
    v_exp_f32 v113, v113
    v_smfmac_f32_32x32x32_bf16 v[40:55], v[152:155], v[104:111], v160
    v_exp_f32 v114, v114
    v_exp_f32 v115, v115
    v_exp_f32 v116, v116
    v_exp_f32 v117, v117
    v_exp_f32 v118, v118
    v_exp_f32 v119, v119
    s_waitcnt lgkmcnt(0)
    v_readfirstlane_b32 s34, v164
    s_nop 0
    s_cmp_ge_u32 s34, 4
    s_cbranch_scc1 M_btok
    s_mov_b32 s35, 30000
SP_15:
    ds_read_b32 v164, v166 offset:44
    s_waitcnt lgkmcnt(0)
    v_readfirstlane_b32 s34, v164
    s_nop 0
    s_cmp_ge_u32 s34, 4
    s_cbranch_scc1 SD_16
    s_sleep 1
    s_sub_u32 s35, s35, 1
    s_cmp_lg_u32 s35, 0
    s_cbranch_scc1 SP_15
SD_16:
M_btok:
    ds_write_b128 v120, v[24:27]
    ds_write_b128 v120, v[28:31] offset:1024
    ds_write_b32 v121, v32 offset:2048
    v_exp_f32 v88, v88
    v_exp_f32 v89, v89
    v_smfmac_f32_32x32x32_bf16 v[40:55], v[156:159], v[112:119], v160
    v_exp_f32 v90, v90
    v_exp_f32 v91, v91
    v_exp_f32 v92, v92
    v_mfma_f32_32x32x16_bf16 v[104:119], v[148:151], v[20:23], 0
    v_exp_f32 v93, v93
    v_exp_f32 v94, v94
    v_exp_f32 v95, v95
    v_exp_f32 v96, v96
    v_exp_f32 v97, v97
    v_smfmac_f32_32x32x32_bf16 v[56:71], v[152:155], v[88:95], v160
    v_exp_f32 v98, v98
    v_exp_f32 v99, v99
    v_exp_f32 v100, v100
    v_exp_f32 v101, v101
    v_exp_f32 v102, v102
    v_exp_f32 v103, v103
    ds_write_b128 v122, v[40:43]
    ds_write_b128 v122, v[44:47] offset:1024
    ds_write_b32 v123, v48 offset:2048
    v_exp_f32 v104, v104
    v_exp_f32 v105, v105
    v_smfmac_f32_32x32x32_bf16 v[56:71], v[156:159], v[96:103], v160
    v_exp_f32 v106, v106
    v_exp_f32 v107, v107
    v_exp_f32 v108, v108
    v_exp_f32 v109, v109
    v_exp_f32 v110, v110
    v_exp_f32 v111, v111
    v_exp_f32 v112, v112
    v_exp_f32 v113, v113
    v_smfmac_f32_32x32x32_bf16 v[72:87], v[152:155], v[104:111], v160
    v_exp_f32 v114, v114
    v_exp_f32 v115, v115
    v_exp_f32 v116, v116
    v_exp_f32 v117, v117
    v_exp_f32 v118, v118
    v_exp_f32 v119, v119
    ds_write_b128 v124, v[56:59]
    ds_write_b128 v124, v[60:63] offset:1024
    ds_write_b32 v125, v64 offset:2048
    s_mov_b64 exec, 1
    ds_add_u32 v165, v167 offset:48
    s_mov_b64 exec, -1
    s_setprio 0
    v_smfmac_f32_32x32x32_bf16 v[72:87], v[156:159], v[112:119], v160
    s_lshl_b32 s29, s21, 1
    s_add_u32 s29, s29, s23
    s_lshl_b32 s29, s29, 15
    s_add_u32 s29, s29, 1048576
    s_lshl_b32 s55, s22, 2
    s_add_u32 s55, s55, s24
    s_lshl_b32 s55, s55, 10
    s_add_u32 s55, s55, s29
    s_mov_b32 s54, 0
    s_mov_b32 s35, 30000
SP_17:
    ds_read_b32 v164, v165 offset:48
    s_waitcnt lgkmcnt(0)
    v_readfirstlane_b32 s34, v164
    s_nop 0
    s_cmp_ge_u32 s34, 4
    s_cbranch_scc1 SD_18
    s_sleep 1
    s_sub_u32 s35, s35, 1
    s_cmp_lg_u32 s35, 0
    s_cbranch_scc1 SP_17
SD_18:
    ds_read_b128 v[24:27], v126 offset:0
    ds_read_b128 v[28:31], v126 offset:1024
    ds_read_b32 v32, v127 offset:2048
    ds_read_b128 v[40:43], v126 offset:2304
    ds_read_b128 v[44:47], v126 offset:3328
    ds_read_b32 v48, v127 offset:4352
    ds_read_b128 v[56:59], v126 offset:4608
    ds_read_b128 v[60:63], v126 offset:5632
    ds_read_b32 v64, v127 offset:6656
    s_waitcnt lgkmcnt(6)
    v_add_f32 v72, v72, v24
    v_add_f32 v73, v73, v25
    v_add_f32 v74, v74, v26
    v_add_f32 v75, v75, v27
    v_add_f32 v76, v76, v28
    v_add_f32 v77, v77, v29
    v_add_f32 v78, v78, v30
    v_add_f32 v79, v79, v31
    v_add_f32 v80, v80, v32
    s_waitcnt lgkmcnt(3)
    v_add_f32 v72, v72, v40
    v_add_f32 v73, v73, v41
    v_add_f32 v74, v74, v42
    v_add_f32 v75, v75, v43
    v_add_f32 v76, v76, v44
    v_add_f32 v77, v77, v45
    v_add_f32 v78, v78, v46
    v_add_f32 v79, v79, v47
    v_add_f32 v80, v80, v48
    s_waitcnt lgkmcnt(0)
    v_add_f32 v72, v72, v56
    v_add_f32 v73, v73, v57
    v_add_f32 v74, v74, v58
    v_add_f32 v75, v75, v59
    v_add_f32 v76, v76, v60
    v_add_f32 v77, v77, v61
    v_add_f32 v78, v78, v62
    v_add_f32 v79, v79, v63
    v_add_f32 v80, v80, v64
M_fin:
    v_rcp_f32 v104, v80
    s_nop 0
    v_mul_f32 v105, v72, v104
    v_mul_f32 v106, v73, v104
    v_mul_f32 v107, v74, v104
    v_mul_f32 v108, v75, v104
    v_mul_f32 v109, v76, v104
    v_mul_f32 v110, v77, v104
    v_mul_f32 v111, v78, v104
    v_mul_f32 v112, v79, v104
    v_cvt_pk_bf16_f32 v88, v105, v106
    v_cvt_pk_bf16_f32 v89, v107, v108
    v_cvt_pk_bf16_f32 v90, v109, v110
    v_cvt_pk_bf16_f32 v91, v111, v112
    buffer_store_dwordx4 v[88:91], v2, s[16:19], s55 offen sc1
    s_cmp_lg_u32 s54, 0
    s_cbranch_scc1 M_ok
    v_max3_f32 v92, abs(v72), abs(v73), abs(v74)
    v_max3_f32 v93, abs(v75), abs(v76), abs(v77)
    v_max3_f32 v94, abs(v78), abs(v79), v80
    v_add_f32 v95, v72, v73
    v_add_f32 v96, v74, v75
    v_add_f32 v97, v76, v77
    v_add_f32 v98, v78, v79
    v_max3_f32 v92, v92, v93, v94
    v_add_f32 v95, v95, v96
    v_add_f32 v97, v97, v98
    v_cmp_nle_f32 vcc, 0x1f800000, v80
    s_mov_b32 s27, 0x71800000
    v_cmp_nge_f32 s[30:31], s27, v92
    s_nop 0
    s_or_b64 vcc, vcc, s[30:31]
    v_cmp_u_f32 s[30:31], v95, v97
    s_nop 0
    s_or_b64 vcc, vcc, s[30:31]
    s_cbranch_vccnz M_slow
M_ok:
    v_lshrrev_b32 v4, 5, v1
    v_bfe_u32 v5, v1, 2, 2
    v_lshl_add_u32 v6, v4, 3, v5
    v_lshlrev_b32 v6, 7, v6
    v_and_b32 v5, 2, v5
    v_lshl_add_u32 v5, v4, 2, v5
    v_bfe_u32 v12, v1, 1, 1
    v_and_b32 v8, 1, v1
    v_bfe_u32 v13, v1, 4, 1
    v_lshl_add_u32 v14, v12, 3, v6
    v_add_u32 v7, s24, v13
    s_lshl_b32 s27, s24, 14
    s_add_u32 s27, s27, 65536
    v_add_u32 v14, s27, v14
    v_add_u32 v9, 0, v7
    v_and_b32 v9, 3, v9
    v_lshl_add_u32 v9, v9, 1, v8
    v_xor_b32 v9, v9, v5
    v_lshl_add_u32 v10, v9, 4, v14
    v_add_u32 v9, 2, v7
    v_and_b32 v9, 3, v9
    v_lshl_add_u32 v9, v9, 1, v8
    v_xor_b32 v9, v9, v5
    v_lshl_add_u32 v11, v9, 4, v14
    ds_read_b64_tr_b16 v[24:25], v10 offset:0
    ds_read_b64_tr_b16 v[26:27], v10 offset:512
    ds_read_b64_tr_b16 v[28:29], v11 offset:0
    ds_read_b64_tr_b16 v[30:31], v11 offset:512
    ds_read_b64_tr_b16 v[32:33], v10 offset:2048
    ds_read_b64_tr_b16 v[34:35], v10 offset:2560
    ds_read_b64_tr_b16 v[36:37], v11 offset:2048
    ds_read_b64_tr_b16 v[38:39], v11 offset:2560
    ds_read_b64_tr_b16 v[40:41], v10 offset:4096
    ds_read_b64_tr_b16 v[42:43], v10 offset:4608
    ds_read_b64_tr_b16 v[44:45], v11 offset:4096
    ds_read_b64_tr_b16 v[46:47], v11 offset:4608
    ds_read_b64_tr_b16 v[48:49], v10 offset:6144
    ds_read_b64_tr_b16 v[50:51], v10 offset:6656
    ds_read_b64_tr_b16 v[52:53], v11 offset:6144
    ds_read_b64_tr_b16 v[54:55], v11 offset:6656
    ds_read_b64_tr_b16 v[56:57], v10 offset:8192
    ds_read_b64_tr_b16 v[58:59], v10 offset:8704
    ds_read_b64_tr_b16 v[60:61], v11 offset:8192
    ds_read_b64_tr_b16 v[62:63], v11 offset:8704
    ds_read_b64_tr_b16 v[64:65], v10 offset:10240
    ds_read_b64_tr_b16 v[66:67], v10 offset:10752
    ds_read_b64_tr_b16 v[68:69], v11 offset:10240
    ds_read_b64_tr_b16 v[70:71], v11 offset:10752
    ds_read_b64_tr_b16 v[72:73], v10 offset:12288
    ds_read_b64_tr_b16 v[74:75], v10 offset:12800
    ds_read_b64_tr_b16 v[76:77], v11 offset:12288
    ds_read_b64_tr_b16 v[78:79], v11 offset:12800
    ds_read_b64_tr_b16 v[80:81], v10 offset:14336
    ds_read_b64_tr_b16 v[82:83], v10 offset:14848
    ds_read_b64_tr_b16 v[84:85], v11 offset:14336
    ds_read_b64_tr_b16 v[86:87], v11 offset:14848
    v_lshl_add_u32 v6, v8, 3, v6
    s_lshl_b32 s27, s23, 1
    v_add_u32 v7, s27, v13
    v_lshl_add_u32 v7, v7, 1, v12
    v_xor_b32 v7, v7, v5
    v_lshl_add_u32 v6, v7, 4, v6
    s_lshl_b32 s27, s24, 11
    s_add_u32 s27, s27, 141568
    v_add_u32 v6, s27, v6
    ds_read_b64_tr_b16 v[152:153], v6
    ds_read_b64_tr_b16 v[154:155], v6 offset:512
    v_and_b32 v7, 31, v1
    s_lshl_b32 s27, s23, 9
    s_add_u32 s27, s27, 140544
    v_lshl_add_u32 v7, v7, 2, s27
    ds_read_b32 v156, v7
    ds_read_b32 v157, v7 offset:128
    ds_read_b32 v158, v7 offset:256
    ds_read_b32 v159, v7 offset:384
    ds_read_b32 v3, v166 offset:12
    s_lshl_b32 s28, s21, 1
    s_add_u32 s28, s28, s23
    s_lshl_b32 s28, s28, 10
    s_add_u32 s28, s28, 327680
    v_mov_b32 v5, 0
    s_lshl_b32 s30, s24, 13
    s_add_u32 s30, s30, s29
    s_add_u32 s31, s30, 4096
    s_waitcnt vmcnt(0)
    s_mov_b64 exec, 1
    ds_add_rtn_u32 v4, v165, v167 offset:52
    s_mov_b64 exec, -1
    s_waitcnt lgkmcnt(0)
    v_readfirstlane_b32 s27, v4
    s_nop 0
    s_cmp_lg_u32 s27, 3
    s_cbranch_scc1 M_nopub
    s_lshl_b32 s27, s22, 7
    s_add_u32 s27, s27, s28
    s_mov_b64 exec, 1
    buffer_store_dword v3, v5, s[16:19], s27 offen sc1
    s_mov_b64 exec, -1
M_nopub:
    v_readfirstlane_b32 s34, v3
    s_lshl_b32 s27, s24, 8
    s_add_u32 s28, s28, s27
    v_lshlrev_b32 v4, 7, v8
    s_mov_b32 s35, 30000
PL_19:
    buffer_load_dword v6, v4, s[16:19], s28 offen sc1
    s_waitcnt vmcnt(0)
    v_cmp_ne_u32 vcc, s34, v6
    s_nop 0
    s_cbranch_vccz PD_20
    s_sleep 1
    s_sub_u32 s35, s35, 1
    s_cmp_lg_u32 s35, 0
    s_cbranch_scc1 PL_19
PD_20:
    buffer_load_dwordx4 v[88:91], v2, s[16:19], s30 offen offset:0 sc1
    buffer_load_dwordx4 v[92:95], v2, s[16:19], s30 offen offset:1024 sc1
    buffer_load_dwordx4 v[96:99], v2, s[16:19], s30 offen offset:2048 sc1
    buffer_load_dwordx4 v[100:103], v2, s[16:19], s30 offen offset:3072 sc1
    buffer_load_dwordx4 v[104:107], v2, s[16:19], s31 offen offset:0 sc1
    buffer_load_dwordx4 v[108:111], v2, s[16:19], s31 offen offset:1024 sc1
    buffer_load_dwordx4 v[112:115], v2, s[16:19], s31 offen offset:2048 sc1
    buffer_load_dwordx4 v[116:119], v2, s[16:19], s31 offen offset:3072 sc1
    v_add_f32 v156, v156, v157
    v_add_f32 v158, v158, v159
    v_add_f32 v156, v156, v158
    v_mul_f32 v156, 0xbfb8aa3b, v156
    v_exp_f32 v156, v156
    s_add_u32 s27, s24, 1
    s_and_b32 s27, s27, 3
    s_lshl_b32 s28, s23, 2
    s_add_u32 s27, s27, s28
    s_mul_i32 s27, s27, 6912
    s_add_u32 s27, s27, 0
    v_add_u32 v12, s27, v2
    s_add_u32 s27, s24, 2
    s_and_b32 s27, s27, 3
    s_lshl_b32 s28, s23, 2
    s_add_u32 s27, s27, s28
    s_mul_i32 s27, s27, 6912
    s_add_u32 s27, s27, 2304
    v_add_u32 v13, s27, v2
    s_add_u32 s27, s24, 3
    s_and_b32 s27, s27, 3
    s_lshl_b32 s28, s23, 2
    s_add_u32 s27, s27, s28
    s_mul_i32 s27, s27, 6912
    s_add_u32 s27, s27, 4608
    v_add_u32 v14, s27, v2
    s_mul_i32 s27, s20, 6912
    s_add_u32 s27, s27, 0
    v_add_u32 v15, s27, v2
    v_add_f32 v156, 1.0, v156
    v_rcp_f32 v156, v156
    s_mov_b32 s8, s46
    s_mov_b32 s9, s47
    s_mov_b32 s10, 2097152
    s_mov_b32 s11, 0x00020000
    v_and_b32 v4, 31, v1
    v_lshlrev_b32 v4, 10, v4
    v_lshrrev_b32 v5, 5, v1
    v_lshl_add_u32 v4, v5, 4, v4
    s_lshl_b32 s27, s21, 16
    s_lshl_b32 s28, s23, 15
    s_add_u32 s27, s27, s28
    s_lshl_b32 s28, s22, 7
    s_add_u32 s27, s27, s28
    s_lshl_b32 s28, s24, 5
    s_add_u32 s27, s27, s28
    v_lshlrev_b32 v16, 16, v152
    v_and_b32 v17, 0xffff0000, v152
    v_lshlrev_b32 v18, 16, v153
    v_and_b32 v19, 0xffff0000, v153
    v_lshlrev_b32 v20, 16, v154
    v_and_b32 v21, 0xffff0000, v154
    v_lshlrev_b32 v22, 16, v155
    v_and_b32 v23, 0xffff0000, v155
    s_mov_b32 s35, 30000
SP_21:
    ds_read_b32 v164, v165 offset:52
    s_waitcnt lgkmcnt(0)
    v_readfirstlane_b32 s34, v164
    s_nop 0
    s_cmp_ge_u32 s34, 4
    s_cbranch_scc1 SD_22
    s_sleep 1
    s_sub_u32 s35, s35, 1
    s_cmp_lg_u32 s35, 0
    s_cbranch_scc1 SP_21
SD_22:
    s_waitcnt vmcnt(7)
    v_mfma_f32_32x32x16_bf16 v[120:135], v[24:27], v[88:91], 0
    v_mfma_f32_32x32x16_bf16 v[136:151], v[28:31], v[88:91], 0
    s_waitcnt vmcnt(6)
    v_mfma_f32_32x32x16_bf16 v[120:135], v[32:35], v[92:95], v[120:135]
    v_mfma_f32_32x32x16_bf16 v[136:151], v[36:39], v[92:95], v[136:151]
    s_waitcnt vmcnt(5)
    v_mfma_f32_32x32x16_bf16 v[120:135], v[40:43], v[96:99], v[120:135]
    v_mfma_f32_32x32x16_bf16 v[136:151], v[44:47], v[96:99], v[136:151]
    s_waitcnt vmcnt(4)
    v_mfma_f32_32x32x16_bf16 v[120:135], v[48:51], v[100:103], v[120:135]
    v_mfma_f32_32x32x16_bf16 v[136:151], v[52:55], v[100:103], v[136:151]
    s_waitcnt vmcnt(3)
    v_mfma_f32_32x32x16_bf16 v[120:135], v[56:59], v[104:107], v[120:135]
    v_mfma_f32_32x32x16_bf16 v[136:151], v[60:63], v[104:107], v[136:151]
    s_waitcnt vmcnt(2)
    v_mfma_f32_32x32x16_bf16 v[120:135], v[64:67], v[108:111], v[120:135]
    v_mfma_f32_32x32x16_bf16 v[136:151], v[68:71], v[108:111], v[136:151]
    s_waitcnt vmcnt(1)
    v_mfma_f32_32x32x16_bf16 v[120:135], v[72:75], v[112:115], v[120:135]
    v_mfma_f32_32x32x16_bf16 v[136:151], v[76:79], v[112:115], v[136:151]
    s_waitcnt vmcnt(0)
    v_mfma_f32_32x32x16_bf16 v[120:135], v[80:83], v[116:119], v[120:135]
    v_mfma_f32_32x32x16_bf16 v[136:151], v[84:87], v[116:119], v[136:151]
    s_nop 10
    ds_write_b128 v12, v[128:131]
    ds_write_b128 v12, v[132:135] offset:1024
    ds_write_b128 v13, v[136:139]
    ds_write_b128 v13, v[140:143] offset:1024
    ds_write_b128 v14, v[144:147]
    ds_write_b128 v14, v[148:151] offset:1024
    s_mov_b64 exec, 1
    ds_add_u32 v165, v167 offset:56
    s_mov_b64 exec, -1
    v_sub_f32 v120, v120, v16
    v_sub_f32 v121, v121, v17
    v_sub_f32 v122, v122, v18
    v_sub_f32 v123, v123, v19
    v_sub_f32 v124, v124, v20
    v_sub_f32 v125, v125, v21
    v_sub_f32 v126, v126, v22
    v_sub_f32 v127, v127, v23
    s_mov_b32 s35, 30000
SP_23:
    ds_read_b32 v164, v165 offset:56
    s_waitcnt lgkmcnt(0)
    v_readfirstlane_b32 s34, v164
    s_nop 0
    s_cmp_ge_u32 s34, 4
    s_cbranch_scc1 SD_24
    s_sleep 1
    s_sub_u32 s35, s35, 1
    s_cmp_lg_u32 s35, 0
    s_cbranch_scc1 SP_23
SD_24:
    ds_read_b128 v[128:131], v15 offset:0
    ds_read_b128 v[132:135], v15 offset:1024
    ds_read_b128 v[136:139], v15 offset:2304
    ds_read_b128 v[140:143], v15 offset:3328
    ds_read_b128 v[144:147], v15 offset:4608
    ds_read_b128 v[148:151], v15 offset:5632
    s_waitcnt lgkmcnt(4)
    v_add_f32 v120, v120, v128
    v_add_f32 v121, v121, v129
    v_add_f32 v122, v122, v130
    v_add_f32 v123, v123, v131
    v_add_f32 v124, v124, v132
    v_add_f32 v125, v125, v133
    v_add_f32 v126, v126, v134
    v_add_f32 v127, v127, v135
    s_waitcnt lgkmcnt(2)
    v_add_f32 v120, v120, v136
    v_add_f32 v121, v121, v137
    v_add_f32 v122, v122, v138
    v_add_f32 v123, v123, v139
    v_add_f32 v124, v124, v140
    v_add_f32 v125, v125, v141
    v_add_f32 v126, v126, v142
    v_add_f32 v127, v127, v143
    s_waitcnt lgkmcnt(0)
    v_add_f32 v120, v120, v144
    v_add_f32 v121, v121, v145
    v_add_f32 v122, v122, v146
    v_add_f32 v123, v123, v147
    v_add_f32 v124, v124, v148
    v_add_f32 v125, v125, v149
    v_add_f32 v126, v126, v150
    v_add_f32 v127, v127, v151
    v_fma_f32 v120, v120, v156, v16
    v_fma_f32 v121, v121, v156, v17
    v_fma_f32 v122, v122, v156, v18
    v_fma_f32 v123, v123, v156, v19
    v_fma_f32 v124, v124, v156, v20
    v_fma_f32 v125, v125, v156, v21
    v_fma_f32 v126, v126, v156, v22
    v_fma_f32 v127, v127, v156, v23
    v_cvt_pk_bf16_f32 v16, v120, v121
    v_cvt_pk_bf16_f32 v17, v122, v123
    v_cvt_pk_bf16_f32 v18, v124, v125
    v_cvt_pk_bf16_f32 v19, v126, v127
    buffer_store_dwordx4 v[16:19], v4, s[8:11], s27 offen
    s_endpgm
M_slow:
    s_mov_b32 s54, 1
    s_mov_b32 s25, 0
    s_mov_b32 s28, 0
    v_mov_b32 v7, 0xff800000
M_slow1:
    buffer_load_dwordx4 v[136:139], v2, s[16:19], s25 offen sc1
    s_add_u32 s25, s25, 1024
    s_waitcnt vmcnt(0)
    v_mfma_f32_32x32x16_bf16 v[88:103], v[136:139], v[20:23], 0
    s_nop 11
    v_max3_f32 v7, v7, v88, v89
    v_max3_f32 v7, v7, v90, v91
    v_max3_f32 v7, v7, v92, v93
    v_max3_f32 v7, v7, v94, v95
    v_max3_f32 v7, v7, v96, v97
    v_max3_f32 v7, v7, v98, v99
    v_max3_f32 v7, v7, v100, v101
    v_max3_f32 v7, v7, v102, v103
    s_add_u32 s28, s28, 1
    s_cmp_lt_u32 s28, 64
    s_cbranch_scc1 M_slow1
    v_mov_b32 v6, v7
    s_nop 1
    v_permlane32_swap_b32 v7, v6
    v_max_f32 v7, v7, v6
    v_sub_f32 v120, 0, v7
    v_sub_f32 v121, 0, v7
    v_sub_f32 v122, 0, v7
    v_sub_f32 v123, 0, v7
    v_sub_f32 v124, 0, v7
    v_sub_f32 v125, 0, v7
    v_sub_f32 v126, 0, v7
    v_sub_f32 v127, 0, v7
    v_sub_f32 v128, 0, v7
    v_sub_f32 v129, 0, v7
    v_sub_f32 v130, 0, v7
    v_sub_f32 v131, 0, v7
    v_sub_f32 v132, 0, v7
    v_sub_f32 v133, 0, v7
    v_sub_f32 v134, 0, v7
    v_sub_f32 v135, 0, v7
    v_mov_b64 v[72:73], 0
    v_mov_b64 v[74:75], 0
    v_mov_b64 v[76:77], 0
    v_mov_b64 v[78:79], 0
    v_mov_b64 v[80:81], 0
    v_mov_b64 v[82:83], 0
    v_mov_b64 v[84:85], 0
    v_mov_b64 v[86:87], 0
    s_mov_b32 s25, 0
    s_mov_b32 s26, 65536
    s_mov_b32 s28, 0
M_slow2:
    buffer_load_dwordx4 v[136:139], v2, s[16:19], s25 offen sc1
    s_add_u32 s25, s25, 1024
    s_mov_b64 exec, s[32:33]
    buffer_load_dwordx4 v[140:143], v3, s[16:19], s26 offen sc1
    buffer_load_dwordx4 v[144:147], v3, s[16:19], s26 offen offset:512 sc1
    s_mov_b64 exec, -1
    s_add_u32 s26, s26, 1024
    s_waitcnt vmcnt(0)
    v_mfma_f32_32x32x16_bf16 v[88:103], v[136:139], v[20:23], v[120:135]
    s_nop 11
    v_exp_f32 v88, v88
    v_exp_f32 v89, v89
    v_exp_f32 v90, v90
    v_exp_f32 v91, v91
    v_exp_f32 v92, v92
    v_exp_f32 v93, v93
    v_exp_f32 v94, v94
    v_exp_f32 v95, v95
    v_exp_f32 v96, v96
    v_exp_f32 v97, v97
    v_exp_f32 v98, v98
    v_exp_f32 v99, v99
    v_exp_f32 v100, v100
    v_exp_f32 v101, v101
    v_exp_f32 v102, v102
    v_exp_f32 v103, v103
    v_smfmac_f32_32x32x32_bf16 v[72:87], v[140:143], v[88:95], v160
    s_nop 0
    v_smfmac_f32_32x32x32_bf16 v[72:87], v[144:147], v[96:103], v160
    s_add_u32 s28, s28, 1
    s_cmp_lt_u32 s28, 64
    s_cbranch_scc1 M_slow2
    s_nop 15
    s_branch M_fin
F_kgen:
    s_setprio 2
    s_mov_b32 s54, s24
    s_lshr_b32 s23, s54, 1
    s_and_b32 s24, s54, 1
    s_lshl_b32 s25, s2, 1
    s_add_u32 s25, s25, s23
    s_lshl_b32 s26, s25, 8
    v_lshlrev_b32 v3, 2, v1
    v_add_u32 v3, s26, v3
    s_lshl_b32 s27, s24, 7
    s_add_u32 s26, s26, s27
    v_lshlrev_b32 v4, 1, v1
    v_add_u32 v4, s26, v4
    s_lshl_b32 s26, s25, 1
    v_mov_b32 v5, s26
    s_lshl_b32 s26, s23, 6
    v_add_u32 v165, s26, v166
    v_mov_b32 v6, 0
    s_waitcnt lgkmcnt(0)
    global_load_ushort v8, v4, s[56:57]
    global_load_ushort v14, v5, s[64:65]
    global_load_ushort v9, v4, s[58:59]
    global_load_dword v12, v3, s[60:61]
    global_load_dword v13, v3, s[62:63]
    global_load_ushort v10, v4, s[60:61]
    global_load_ushort v11, v4, s[62:63]
    global_load_ushort v15, v5, s[66:67]
    s_barrier
    s_mov_b32 s16, s50
    s_mov_b32 s17, s51
    s_mov_b32 s18, 16777216
    s_mov_b32 s19, 0x00020000
    s_mul_i32 s28, s54, 4352
    s_add_u32 s28, s28, 141568
    s_mul_i32 s29, s23, 1424
    s_add_u32 s29, s29, 158976
    v_mov_b32 v22, s29
    v_mov_b32 v23, 0x3f800000
    ds_write_b32 v22, v23 offset:1408
    s_add_u32 s27, s29, 1408
    v_mov_b32 v23, s27
    s_cmp_eq_u32 s24, 0
    s_cbranch_scc1 G_lo
    v_lshlrev_b32 v16, 3, v1
    v_sub_u32 v16, 1023, v16
    v_cvt_f32_i32 v17, v16
    s_add_u32 s26, s29, 4294933248
    v_mov_b32 v18, s26
    v_mov_b32 v19, 2
    v_add_f32 v20, 0x80000000, v17
    v_add_f32 v21, 0xbf800000, v17
    v_cvt_pk_bf16_f32 v20, v20, v21
    v_mad_u32_u16 v128, v20, v19, v18
    v_mad_u32_u16 v129, v20, v19, v18 op_sel:[1,0,0,0]
    v_add_f32 v20, 0xc0000000, v17
    v_add_f32 v21, 0xc0400000, v17
    v_cvt_pk_bf16_f32 v20, v20, v21
    v_mad_u32_u16 v130, v20, v19, v18
    v_mad_u32_u16 v131, v20, v19, v18 op_sel:[1,0,0,0]
    v_add_f32 v20, 0xc0800000, v17
    v_add_f32 v21, 0xc0a00000, v17
    v_cvt_pk_bf16_f32 v20, v20, v21
    v_mad_u32_u16 v132, v20, v19, v18
    v_mad_u32_u16 v133, v20, v19, v18 op_sel:[1,0,0,0]
    v_add_f32 v20, 0xc0c00000, v17
    v_add_f32 v21, 0xc0e00000, v17
    v_cvt_pk_bf16_f32 v20, v20, v21
    v_mad_u32_u16 v134, v20, v19, v18
    v_mad_u32_u16 v135, v20, v19, v18 op_sel:[1,0,0,0]
    v_add_f32 v20, 0xc1000000, v17
    v_add_f32 v21, 0xc4000000, v17
    v_cvt_pk_bf16_f32 v20, v20, v21
    v_mad_u32_u16 v136, v20, v19, v18
    v_mad_u32_u16 v137, v20, v19, v18 op_sel:[1,0,0,0]
    v_add_f32 v20, 0xc4004000, v17
    v_add_f32 v21, 0xc4008000, v17
    v_cvt_pk_bf16_f32 v20, v20, v21
    v_mad_u32_u16 v138, v20, v19, v18
    v_mad_u32_u16 v139, v20, v19, v18 op_sel:[1,0,0,0]
    v_add_f32 v20, 0xc400c000, v17
    v_add_f32 v21, 0xc4010000, v17
    v_cvt_pk_bf16_f32 v20, v20, v21
    v_mad_u32_u16 v140, v20, v19, v18
    v_mad_u32_u16 v141, v20, v19, v18 op_sel:[1,0,0,0]
    v_add_f32 v20, 0xc4014000, v17
    v_add_f32 v21, 0xc4018000, v17
    v_cvt_pk_bf16_f32 v20, v20, v21
    v_mad_u32_u16 v142, v20, v19, v18
    v_mad_u32_u16 v143, v20, v19, v18 op_sel:[1,0,0,0]
    v_add_f32 v20, 0xc401c000, v17
    v_add_f32 v21, 0xc4020000, v17
    v_max_f32 v21, 0, v21
    v_cvt_pk_bf16_f32 v20, v20, v21
    v_mad_u32_u16 v144, v20, v19, v18
    v_mad_u32_u16 v145, v20, v19, v18 op_sel:[1,0,0,0]
    v_mov_b32 v22, 0x80
    v_subrev_u32 v20, 512, v16
    v_med3_i32 v20, v20, 0, v22
    v_lshl_add_u32 v20, v20, 1, s29
    v_max_i32 v137, v137, v20
    v_subrev_u32 v20, 513, v16
    v_med3_i32 v20, v20, 0, v22
    v_lshl_add_u32 v20, v20, 1, s29
    v_max_i32 v138, v138, v20
    v_subrev_u32 v20, 514, v16
    v_med3_i32 v20, v20, 0, v22
    v_lshl_add_u32 v20, v20, 1, s29
    v_max_i32 v139, v139, v20
    v_subrev_u32 v20, 515, v16
    v_med3_i32 v20, v20, 0, v22
    v_lshl_add_u32 v20, v20, 1, s29
    v_max_i32 v140, v140, v20
    v_subrev_u32 v20, 516, v16
    v_med3_i32 v20, v20, 0, v22
    v_lshl_add_u32 v20, v20, 1, s29
    v_max_i32 v141, v141, v20
    v_subrev_u32 v20, 517, v16
    v_med3_i32 v20, v20, 0, v22
    v_lshl_add_u32 v20, v20, 1, s29
    v_max_i32 v142, v142, v20
    v_subrev_u32 v20, 518, v16
    v_med3_i32 v20, v20, 0, v22
    v_lshl_add_u32 v20, v20, 1, s29
    v_max_i32 v143, v143, v20
    v_subrev_u32 v20, 519, v16
    v_med3_i32 v20, v20, 0, v22
    v_lshl_add_u32 v20, v20, 1, s29
    v_max_i32 v144, v144, v20
    v_subrev_u32 v20, 520, v16
    v_med3_i32 v20, v20, 0, v22
    v_lshl_add_u32 v20, v20, 1, s29
    v_max_i32 v145, v145, v20
    v_cmp_gt_i32 vcc, 520, v16
    s_nop 1
    v_cndmask_b32 v145, v145, v23, vcc
    s_branch G_lj
G_lo:
    v_and_b32 v16, 7, v1
    v_lshlrev_b32 v16, 3, v16
    v_lshrrev_b32 v17, 3, v1
    v_lshlrev_b32 v18, 2, v16
    v_sub_u32 v17, v17, v18
    v_add_u32 v17, 637, v17
    v_lshl_add_u32 v17, v17, 1, s29
    v_cmp_lt_u32 vcc, 41, v1
    s_nop 1
    v_cndmask_b32 v18, 0, 1, vcc
    v_mul_u32_u24 v19, 80, v18
    v_lshlrev_b32 v20, 3, v1
    v_sub_u32 v19, v20, v19
    v_add_u32 v19, v19, v18
    v_subrev_u32 v19, 292, v19
    v_lshlrev_b32 v18, 1, v18
    v_add_u32 v18, 6, v18
    v_add_u32 v22, 2, v23
    v_cmp_gt_u32 s[26:27], 32, v1
    s_add_u32 s32, s29, 1024
    v_mov_b32 v24, s32
    v_add_u32 v21, 0, v19
    v_cmp_le_u32 vcc, v21, v18
    v_subrev_u32 v25, 0, v17
    s_nop 0
    v_cndmask_b32 v128, v23, v22, vcc
    v_cmp_gt_u32 vcc, 32, v16
    s_nop 0
    s_and_b64 vcc, vcc, s[26:27]
    v_cndmask_b32 v128, v128, v25, vcc
    v_cmp_lt_u32 vcc, 506, v20
    s_nop 1
    v_cndmask_b32 v137, v23, v24, vcc
    v_add_u32 v21, 1, v19
    v_cmp_le_u32 vcc, v21, v18
    v_subrev_u32 v25, 8, v17
    s_nop 0
    v_cndmask_b32 v129, v23, v22, vcc
    v_cmp_gt_u32 vcc, 31, v16
    s_nop 0
    s_and_b64 vcc, vcc, s[26:27]
    v_cndmask_b32 v129, v129, v25, vcc
    v_cmp_lt_u32 vcc, 505, v20
    s_nop 1
    v_cndmask_b32 v138, v23, v24, vcc
    v_add_u32 v21, 2, v19
    v_cmp_le_u32 vcc, v21, v18
    v_subrev_u32 v25, 16, v17
    s_nop 0
    v_cndmask_b32 v130, v23, v22, vcc
    v_cmp_gt_u32 vcc, 30, v16
    s_nop 0
    s_and_b64 vcc, vcc, s[26:27]
    v_cndmask_b32 v130, v130, v25, vcc
    v_cmp_lt_u32 vcc, 504, v20
    s_nop 1
    v_cndmask_b32 v139, v23, v24, vcc
    v_add_u32 v21, 3, v19
    v_cmp_le_u32 vcc, v21, v18
    v_subrev_u32 v25, 24, v17
    s_nop 0
    v_cndmask_b32 v131, v23, v22, vcc
    v_cmp_gt_u32 vcc, 29, v16
    s_nop 0
    s_and_b64 vcc, vcc, s[26:27]
    v_cndmask_b32 v131, v131, v25, vcc
    v_cmp_lt_u32 vcc, 503, v20
    s_nop 1
    v_cndmask_b32 v140, v23, v24, vcc
    v_add_u32 v21, 4, v19
    v_cmp_le_u32 vcc, v21, v18
    v_subrev_u32 v25, 32, v17
    s_nop 0
    v_cndmask_b32 v132, v23, v22, vcc
    v_cmp_gt_u32 vcc, 28, v16
    s_nop 0
    s_and_b64 vcc, vcc, s[26:27]
    v_cndmask_b32 v132, v132, v25, vcc
    v_cmp_lt_u32 vcc, 502, v20
    s_nop 1
    v_cndmask_b32 v141, v23, v24, vcc
    v_add_u32 v21, 5, v19
    v_cmp_le_u32 vcc, v21, v18
    v_subrev_u32 v25, 40, v17
    s_nop 0
    v_cndmask_b32 v133, v23, v22, vcc
    v_cmp_gt_u32 vcc, 27, v16
    s_nop 0
    s_and_b64 vcc, vcc, s[26:27]
    v_cndmask_b32 v133, v133, v25, vcc
    v_cmp_lt_u32 vcc, 501, v20
    s_nop 1
    v_cndmask_b32 v142, v23, v24, vcc
    v_add_u32 v21, 6, v19
    v_cmp_le_u32 vcc, v21, v18
    v_subrev_u32 v25, 48, v17
    s_nop 0
    v_cndmask_b32 v134, v23, v22, vcc
    v_cmp_gt_u32 vcc, 26, v16
    s_nop 0
    s_and_b64 vcc, vcc, s[26:27]
    v_cndmask_b32 v134, v134, v25, vcc
    v_cmp_lt_u32 vcc, 500, v20
    s_nop 1
    v_cndmask_b32 v143, v23, v24, vcc
    v_add_u32 v21, 7, v19
    v_cmp_le_u32 vcc, v21, v18
    v_subrev_u32 v25, 56, v17
    s_nop 0
    v_cndmask_b32 v135, v23, v22, vcc
    v_cmp_gt_u32 vcc, 25, v16
    s_nop 0
    s_and_b64 vcc, vcc, s[26:27]
    v_cndmask_b32 v135, v135, v25, vcc
    v_cmp_lt_u32 vcc, 499, v20
    s_nop 1
    v_cndmask_b32 v144, v23, v24, vcc
    v_add_u32 v21, 8, v19
    v_cmp_le_u32 vcc, v21, v18
    v_subrev_u32 v25, 64, v17
    s_nop 0
    v_cndmask_b32 v136, v23, v22, vcc
    v_cmp_gt_u32 vcc, 24, v16
    s_nop 0
    s_and_b64 vcc, vcc, s[26:27]
    v_cndmask_b32 v136, v136, v25, vcc
    v_cmp_lt_u32 vcc, 498, v20
    s_nop 1
    v_cndmask_b32 v145, v23, v24, vcc
G_lj:
    v_and_b32 v20, 31, v1
    v_lshrrev_b32 v21, 5, v1
    v_mov_b32 v16, 1
    v_mov_b32 v17, 672
    v_cmp_eq_u32 vcc, 24, v20
    v_mov_b32 v22, 640
    s_nop 0
    v_cndmask_b32 v17, v17, v22, vcc
    v_bfe_u32 v22, v20, 1, 1
    v_lshlrev_b32 v22, 6, v22
    v_and_b32 v23, 1, v20
    v_add_u32 v22, v22, v23
    v_add_u32 v22, 512, v22
    v_cmp_gt_u32 vcc, 24, v20
    v_mov_b32 v23, 2
    s_nop 0
    v_cndmask_b32 v17, v17, v22, vcc
    v_cndmask_b32 v16, v16, v23, vcc
    v_add_u32 v22, 368, v20
    v_cmp_gt_u32 vcc, 20, v20
    v_mov_b32 v23, 4
    s_nop 0
    v_cndmask_b32 v17, v17, v22, vcc
    v_cndmask_b32 v16, v16, v23, vcc
    s_cmp_eq_u32 s24, 1
    s_cbranch_scc1 G_hi
    v_cmp_gt_u32 vcc, 16, v20
    v_mov_b32 v23, 16
    s_nop 0
    v_cndmask_b32 v17, v17, v20, vcc
    v_cndmask_b32 v16, v16, v23, vcc
    s_mov_b32 s30, 0x0000ffff
    s_branch G_hj
G_hi:
    v_cmp_gt_u32 vcc, 16, v20
    v_lshrrev_b32 v22, 1, v20
    v_add_u32 v22, 128, v22
    v_mov_b32 v23, 8
    v_cndmask_b32 v17, v17, v22, vcc
    v_cndmask_b32 v16, v16, v23, vcc
    v_and_b32 v22, 17, v20
    v_cmp_eq_u32 vcc, 1, v22
    v_mov_b32 v22, 656
    v_mov_b32 v23, 1
    v_cndmask_b32 v17, v17, v22, vcc
    v_cndmask_b32 v16, v16, v23, vcc
    s_mov_b32 s30, 0xffff0000
G_hj:
    s_mov_b32 s31, s30
    s_lshl_b32 s26, s24, 4
    v_lshl_add_u32 v22, v21, 2, s26
    v_mad_u32_u24 v17, v16, v22, v17
    v_lshl_add_u32 v17, v17, 1, s29
    v_lshlrev_b32 v16, 1, v16
    v_lshl_add_u32 v18, v1, 2, s28
    v_and_b32 v22, 15, v1
    v_mul_u32_u24 v19, 272, v22
    v_lshl_add_u32 v19, v21, 4, v19
    v_add_u32 v19, s28, v19
    v_mad_u32_u24 v156, v16, 0, v17
    v_mad_u32_u24 v157, v16, 1, v17
    v_mad_u32_u24 v158, v16, 2, v17
    v_mad_u32_u24 v159, v16, 3, v17
    v_mad_u32_u24 v160, v16, 8, v17
    v_mad_u32_u24 v161, v16, 9, v17
    v_mad_u32_u24 v162, v16, 10, v17
    v_mad_u32_u24 v163, v16, 11, v17
    s_waitcnt vmcnt(0)
    v_lshlrev_b32 v14, 16, v14
    v_lshlrev_b32 v8, 16, v8
    v_lshlrev_b32 v15, 16, v15
    v_lshlrev_b32 v9, 16, v9
    v_and_b32 v12, 0x7fff7fff, v12
    v_and_b32 v13, 0x7fff7fff, v13
    v_pk_max_u16 v12, v12, v13
    v_lshrrev_b32 v13, 16, v12
    v_and_b32 v12, 0xffff, v12
    v_max_u32 v12, v12, v13
    v_mul_f32 v20, 0x3fb8aa00, v14
    v_exp_f32 v20, v20
    v_mov_b32 v24, 1.0
    v_fmac_f32 v24, 0x36a407db, v14
    v_mul_f32 v24, v24, v20
    v_mul_f32 v21, 0x3fb8aa00, v8
    v_exp_f32 v21, v21
    v_mov_b32 v25, 1.0
    v_fmac_f32 v25, 0x36a407db, v8
    v_mul_f32 v25, v25, v21
    v_max_u32_dpp v12, v12, v12 quad_perm:[1,0,3,2] row_mask:0xf bank_mask:0xf
    s_nop 1
    v_max_u32_dpp v12, v12, v12 quad_perm:[2,3,0,1] row_mask:0xf bank_mask:0xf
    s_nop 1
    v_max_u32_dpp v12, v12, v12 row_half_mirror row_mask:0xf bank_mask:0xf
    s_nop 1
    v_max_u32_dpp v12, v12, v12 row_mirror row_mask:0xf bank_mask:0xf
    s_nop 1
    v_max_u32_dpp v12, v12, v12 row_bcast:15 row_mask:0xa bank_mask:0xf
    s_nop 1
    v_max_u32_dpp v12, v12, v12 row_bcast:31 row_mask:0xc bank_mask:0xf
    v_cvt_pk_bf16_f32 v25, v24, v25
    v_lshlrev_b32 v24, 16, v25
    v_and_b32 v25, 0xffff0000, v25
    v_mul_f32 v25, v25, v24
    v_mul_f32 v26, v9, v24
    v_mul_f32 v25, 0xbfb8aa3b, v25
    v_mul_f32 v26, 0.15915494, v26
    v_readlane_b32 s26, v12, 63
    v_mul_f32 v20, 0x3f800000, v25
    v_mul_f32 v21, 0x3f800000, v26
    v_exp_f32 v20, v20
    v_fract_f32 v21, v21
    v_cos_f32 v28, v21
    v_sin_f32 v29, v21
    v_mul_f32 v28, v28, v20
    v_mul_f32 v29, v29, v20
    v_mul_f32 v20, 0x41800000, v25
    v_mul_f32 v21, 0x41800000, v26
    v_exp_f32 v20, v20
    v_fract_f32 v21, v21
    v_cos_f32 v30, v21
    v_sin_f32 v31, v21
    v_mul_f32 v30, v30, v20
    v_mul_f32 v31, v31, v20
    v_mul_f32 v20, 0x44000000, v25
    v_mul_f32 v21, 0x44000000, v26
    v_exp_f32 v20, v20
    v_fract_f32 v21, v21
    v_cos_f32 v32, v21
    v_sin_f32 v33, v21
    v_mul_f32 v32, v32, v20
    v_mul_f32 v33, v33, v20
    s_lshr_b32 s26, s26, 7
    s_max_u32 s26, s26, 27
    s_min_u32 s26, s26, 254
    s_sub_u32 s27, 267, s26
    s_lshl_b32 s27, s27, 23
    s_sub_u32 s26, s26, 26
    s_lshl_b32 s26, s26, 23
    v_mul_f32 v24, s26, v24
    v_lshlrev_b32 v36, 16, v10
    v_lshlrev_b32 v37, 16, v11
    v_mul_f32 v36, s27, v36
    v_mul_f32 v37, s27, v37
    s_mov_b32 s26, 0
G_rows:
    v_cvt_pk_f16_f32 v38, v36, -v37
    ds_write_b32 v18, v38 offset:0
    v_pk_mul_f32 v[34:35], v[36:37], v[30:31] op_sel:[0,0] op_sel_hi:[1,0]
    v_pk_fma_f32 v[36:37], v[36:37], v[30:31], v[34:35] op_sel:[1,1,0] op_sel_hi:[0,1,1] neg_lo:[0,1,0]
    v_cvt_pk_f16_f32 v39, v36, -v37
    ds_write_b32 v18, v39 offset:272
    v_pk_mul_f32 v[34:35], v[36:37], v[30:31] op_sel:[0,0] op_sel_hi:[1,0]
    v_pk_fma_f32 v[36:37], v[36:37], v[30:31], v[34:35] op_sel:[1,1,0] op_sel_hi:[0,1,1] neg_lo:[0,1,0]
    v_cvt_pk_f16_f32 v40, v36, -v37
    ds_write_b32 v18, v40 offset:544
    v_pk_mul_f32 v[34:35], v[36:37], v[30:31] op_sel:[0,0] op_sel_hi:[1,0]
    v_pk_fma_f32 v[36:37], v[36:37], v[30:31], v[34:35] op_sel:[1,1,0] op_sel_hi:[0,1,1] neg_lo:[0,1,0]
    v_cvt_pk_f16_f32 v41, v36, -v37
    ds_write_b32 v18, v41 offset:816
    v_pk_mul_f32 v[34:35], v[36:37], v[30:31] op_sel:[0,0] op_sel_hi:[1,0]
    v_pk_fma_f32 v[36:37], v[36:37], v[30:31], v[34:35] op_sel:[1,1,0] op_sel_hi:[0,1,1] neg_lo:[0,1,0]
    v_cvt_pk_f16_f32 v38, v36, -v37
    ds_write_b32 v18, v38 offset:1088
    v_pk_mul_f32 v[34:35], v[36:37], v[30:31] op_sel:[0,0] op_sel_hi:[1,0]
    v_pk_fma_f32 v[36:37], v[36:37], v[30:31], v[34:35] op_sel:[1,1,0] op_sel_hi:[0,1,1] neg_lo:[0,1,0]
    v_cvt_pk_f16_f32 v39, v36, -v37
    ds_write_b32 v18, v39 offset:1360
    v_pk_mul_f32 v[34:35], v[36:37], v[30:31] op_sel:[0,0] op_sel_hi:[1,0]
    v_pk_fma_f32 v[36:37], v[36:37], v[30:31], v[34:35] op_sel:[1,1,0] op_sel_hi:[0,1,1] neg_lo:[0,1,0]
    v_cvt_pk_f16_f32 v40, v36, -v37
    ds_write_b32 v18, v40 offset:1632
    v_pk_mul_f32 v[34:35], v[36:37], v[30:31] op_sel:[0,0] op_sel_hi:[1,0]
    v_pk_fma_f32 v[36:37], v[36:37], v[30:31], v[34:35] op_sel:[1,1,0] op_sel_hi:[0,1,1] neg_lo:[0,1,0]
    v_cvt_pk_f16_f32 v41, v36, -v37
    ds_write_b32 v18, v41 offset:1904
    v_pk_mul_f32 v[34:35], v[36:37], v[30:31] op_sel:[0,0] op_sel_hi:[1,0]
    v_pk_fma_f32 v[36:37], v[36:37], v[30:31], v[34:35] op_sel:[1,1,0] op_sel_hi:[0,1,1] neg_lo:[0,1,0]
    v_cvt_pk_f16_f32 v38, v36, -v37
    ds_write_b32 v18, v38 offset:2176
    v_pk_mul_f32 v[34:35], v[36:37], v[30:31] op_sel:[0,0] op_sel_hi:[1,0]
    v_pk_fma_f32 v[36:37], v[36:37], v[30:31], v[34:35] op_sel:[1,1,0] op_sel_hi:[0,1,1] neg_lo:[0,1,0]
    v_cvt_pk_f16_f32 v39, v36, -v37
    ds_write_b32 v18, v39 offset:2448
    v_pk_mul_f32 v[34:35], v[36:37], v[30:31] op_sel:[0,0] op_sel_hi:[1,0]
    v_pk_fma_f32 v[36:37], v[36:37], v[30:31], v[34:35] op_sel:[1,1,0] op_sel_hi:[0,1,1] neg_lo:[0,1,0]
    v_cvt_pk_f16_f32 v40, v36, -v37
    ds_write_b32 v18, v40 offset:2720
    v_pk_mul_f32 v[34:35], v[36:37], v[30:31] op_sel:[0,0] op_sel_hi:[1,0]
    v_pk_fma_f32 v[36:37], v[36:37], v[30:31], v[34:35] op_sel:[1,1,0] op_sel_hi:[0,1,1] neg_lo:[0,1,0]
    v_cvt_pk_f16_f32 v41, v36, -v37
    ds_write_b32 v18, v41 offset:2992
    v_pk_mul_f32 v[34:35], v[36:37], v[30:31] op_sel:[0,0] op_sel_hi:[1,0]
    v_pk_fma_f32 v[36:37], v[36:37], v[30:31], v[34:35] op_sel:[1,1,0] op_sel_hi:[0,1,1] neg_lo:[0,1,0]
    v_cvt_pk_f16_f32 v38, v36, -v37
    ds_write_b32 v18, v38 offset:3264
    v_pk_mul_f32 v[34:35], v[36:37], v[30:31] op_sel:[0,0] op_sel_hi:[1,0]
    v_pk_fma_f32 v[36:37], v[36:37], v[30:31], v[34:35] op_sel:[1,1,0] op_sel_hi:[0,1,1] neg_lo:[0,1,0]
    v_cvt_pk_f16_f32 v39, v36, -v37
    ds_write_b32 v18, v39 offset:3536
    v_pk_mul_f32 v[34:35], v[36:37], v[30:31] op_sel:[0,0] op_sel_hi:[1,0]
    v_pk_fma_f32 v[36:37], v[36:37], v[30:31], v[34:35] op_sel:[1,1,0] op_sel_hi:[0,1,1] neg_lo:[0,1,0]
    v_cvt_pk_f16_f32 v40, v36, -v37
    ds_write_b32 v18, v40 offset:3808
    v_pk_mul_f32 v[34:35], v[36:37], v[30:31] op_sel:[0,0] op_sel_hi:[1,0]
    v_pk_fma_f32 v[36:37], v[36:37], v[30:31], v[34:35] op_sel:[1,1,0] op_sel_hi:[0,1,1] neg_lo:[0,1,0]
    v_cvt_pk_f16_f32 v41, v36, -v37
    ds_write_b32 v18, v41 offset:4080
    v_pk_mul_f32 v[34:35], v[36:37], v[30:31] op_sel:[0,0] op_sel_hi:[1,0]
    v_pk_fma_f32 v[36:37], v[36:37], v[30:31], v[34:35] op_sel:[1,1,0] op_sel_hi:[0,1,1] neg_lo:[0,1,0]
    s_mov_b64 exec, s[30:31]
    ds_read_b128 v[64:67], v19 offset:0
    ds_read_b128 v[68:71], v19 offset:32
    ds_read_b128 v[72:75], v19 offset:64
    ds_read_b128 v[76:79], v19 offset:96
    ds_read_b128 v[80:83], v19 offset:128
    ds_read_b128 v[84:87], v19 offset:160
    ds_read_b128 v[88:91], v19 offset:192
    ds_read_b128 v[92:95], v19 offset:224
    s_mov_b64 exec, -1
    s_not_b64 s[30:31], s[30:31]
    s_add_u32 s26, s26, 1
    s_cmp_lt_u32 s26, 2
    s_cbranch_scc1 G_rows
    v_mov_b32 v36, 0x46800000
    v_mov_b32 v37, 0
    s_mov_b32 s30, 0x0000ffff
    s_mov_b32 s31, 0x0000ffff
    v_cvt_pk_f16_f32 v38, v36, v37
    ds_write_b32 v18, v38 offset:0
    v_pk_mul_f32 v[42:43], v[36:37], v[32:33] op_sel:[0,0] op_sel_hi:[1,0]
    v_pk_fma_f32 v[148:149], v[36:37], v[32:33], v[42:43] op_sel:[1,1,0] op_sel_hi:[0,1,1] neg_lo:[0,1,0]
    v_pk_mul_f32 v[34:35], v[36:37], v[28:29] op_sel:[0,0] op_sel_hi:[1,0]
    v_pk_fma_f32 v[36:37], v[36:37], v[28:29], v[34:35] op_sel:[1,1,0] op_sel_hi:[0,1,1] neg_lo:[0,1,0]
    v_cvt_pk_f16_f32 v39, v36, v37
    ds_write_b32 v18, v39 offset:272
    v_pk_mul_f32 v[34:35], v[36:37], v[28:29] op_sel:[0,0] op_sel_hi:[1,0]
    v_pk_fma_f32 v[36:37], v[36:37], v[28:29], v[34:35] op_sel:[1,1,0] op_sel_hi:[0,1,1] neg_lo:[0,1,0]
    v_cvt_pk_f16_f32 v40, v36, v37
    ds_write_b32 v18, v40 offset:544
    v_pk_mul_f32 v[34:35], v[36:37], v[28:29] op_sel:[0,0] op_sel_hi:[1,0]
    v_pk_fma_f32 v[36:37], v[36:37], v[28:29], v[34:35] op_sel:[1,1,0] op_sel_hi:[0,1,1] neg_lo:[0,1,0]
    v_cvt_pk_f16_f32 v41, v36, v37
    ds_write_b32 v18, v41 offset:816
    v_pk_mul_f32 v[34:35], v[36:37], v[28:29] op_sel:[0,0] op_sel_hi:[1,0]
    v_pk_fma_f32 v[36:37], v[36:37], v[28:29], v[34:35] op_sel:[1,1,0] op_sel_hi:[0,1,1] neg_lo:[0,1,0]
    v_cvt_pk_f16_f32 v38, v36, v37
    ds_write_b32 v18, v38 offset:1088
    v_pk_mul_f32 v[42:43], v[36:37], v[32:33] op_sel:[0,0] op_sel_hi:[1,0]
    v_pk_fma_f32 v[150:151], v[36:37], v[32:33], v[42:43] op_sel:[1,1,0] op_sel_hi:[0,1,1] neg_lo:[0,1,0]
    v_pk_mul_f32 v[34:35], v[36:37], v[28:29] op_sel:[0,0] op_sel_hi:[1,0]
    v_pk_fma_f32 v[36:37], v[36:37], v[28:29], v[34:35] op_sel:[1,1,0] op_sel_hi:[0,1,1] neg_lo:[0,1,0]
    v_cvt_pk_f16_f32 v39, v36, v37
    ds_write_b32 v18, v39 offset:1360
    v_pk_mul_f32 v[34:35], v[36:37], v[28:29] op_sel:[0,0] op_sel_hi:[1,0]
    v_pk_fma_f32 v[36:37], v[36:37], v[28:29], v[34:35] op_sel:[1,1,0] op_sel_hi:[0,1,1] neg_lo:[0,1,0]
    v_cvt_pk_f16_f32 v40, v36, v37
    ds_write_b32 v18, v40 offset:1632
    v_pk_mul_f32 v[34:35], v[36:37], v[28:29] op_sel:[0,0] op_sel_hi:[1,0]
    v_pk_fma_f32 v[36:37], v[36:37], v[28:29], v[34:35] op_sel:[1,1,0] op_sel_hi:[0,1,1] neg_lo:[0,1,0]
    v_cvt_pk_f16_f32 v41, v36, v37
    ds_write_b32 v18, v41 offset:1904
    v_pk_mul_f32 v[34:35], v[36:37], v[28:29] op_sel:[0,0] op_sel_hi:[1,0]
    v_pk_fma_f32 v[36:37], v[36:37], v[28:29], v[34:35] op_sel:[1,1,0] op_sel_hi:[0,1,1] neg_lo:[0,1,0]
    v_cvt_pk_f16_f32 v38, v36, v37
    ds_write_b32 v18, v38 offset:2176
    v_pk_mul_f32 v[42:43], v[36:37], v[32:33] op_sel:[0,0] op_sel_hi:[1,0]
    v_pk_fma_f32 v[152:153], v[36:37], v[32:33], v[42:43] op_sel:[1,1,0] op_sel_hi:[0,1,1] neg_lo:[0,1,0]
    v_pk_mul_f32 v[34:35], v[36:37], v[28:29] op_sel:[0,0] op_sel_hi:[1,0]
    v_pk_fma_f32 v[36:37], v[36:37], v[28:29], v[34:35] op_sel:[1,1,0] op_sel_hi:[0,1,1] neg_lo:[0,1,0]
    v_cvt_pk_f16_f32 v39, v36, v37
    ds_write_b32 v18, v39 offset:2448
    v_pk_mul_f32 v[34:35], v[36:37], v[28:29] op_sel:[0,0] op_sel_hi:[1,0]
    v_pk_fma_f32 v[36:37], v[36:37], v[28:29], v[34:35] op_sel:[1,1,0] op_sel_hi:[0,1,1] neg_lo:[0,1,0]
    v_cvt_pk_f16_f32 v40, v36, v37
    ds_write_b32 v18, v40 offset:2720
    v_pk_mul_f32 v[34:35], v[36:37], v[28:29] op_sel:[0,0] op_sel_hi:[1,0]
    v_pk_fma_f32 v[36:37], v[36:37], v[28:29], v[34:35] op_sel:[1,1,0] op_sel_hi:[0,1,1] neg_lo:[0,1,0]
    v_cvt_pk_f16_f32 v41, v36, v37
    ds_write_b32 v18, v41 offset:2992
    v_pk_mul_f32 v[34:35], v[36:37], v[28:29] op_sel:[0,0] op_sel_hi:[1,0]
    v_pk_fma_f32 v[36:37], v[36:37], v[28:29], v[34:35] op_sel:[1,1,0] op_sel_hi:[0,1,1] neg_lo:[0,1,0]
    v_cvt_pk_f16_f32 v38, v36, v37
    ds_write_b32 v18, v38 offset:3264
    v_pk_mul_f32 v[42:43], v[36:37], v[32:33] op_sel:[0,0] op_sel_hi:[1,0]
    v_pk_fma_f32 v[154:155], v[36:37], v[32:33], v[42:43] op_sel:[1,1,0] op_sel_hi:[0,1,1] neg_lo:[0,1,0]
    v_pk_mul_f32 v[34:35], v[36:37], v[28:29] op_sel:[0,0] op_sel_hi:[1,0]
    v_pk_fma_f32 v[36:37], v[36:37], v[28:29], v[34:35] op_sel:[1,1,0] op_sel_hi:[0,1,1] neg_lo:[0,1,0]
    v_cvt_pk_f16_f32 v39, v36, v37
    ds_write_b32 v18, v39 offset:3536
    v_pk_mul_f32 v[34:35], v[36:37], v[28:29] op_sel:[0,0] op_sel_hi:[1,0]
    v_pk_fma_f32 v[36:37], v[36:37], v[28:29], v[34:35] op_sel:[1,1,0] op_sel_hi:[0,1,1] neg_lo:[0,1,0]
    v_cvt_pk_f16_f32 v40, v36, v37
    ds_write_b32 v18, v40 offset:3808
    v_pk_mul_f32 v[34:35], v[36:37], v[28:29] op_sel:[0,0] op_sel_hi:[1,0]
    v_pk_fma_f32 v[36:37], v[36:37], v[28:29], v[34:35] op_sel:[1,1,0] op_sel_hi:[0,1,1] neg_lo:[0,1,0]
    v_cvt_pk_f16_f32 v41, v36, v37
    ds_write_b32 v18, v41 offset:4080
    s_mov_b64 exec, s[30:31]
    ds_read_b128 v[96:99], v19 offset:0
    ds_read_b128 v[100:103], v19 offset:32
    ds_read_b128 v[104:107], v19 offset:64
    ds_read_b128 v[108:111], v19 offset:96
    ds_read_b128 v[112:115], v19 offset:128
    ds_read_b128 v[116:119], v19 offset:160
    ds_read_b128 v[120:123], v19 offset:192
    ds_read_b128 v[124:127], v19 offset:224
    s_mov_b64 exec, -1
    v_cvt_pk_f16_f32 v38, v148, v149
    ds_write_b32 v18, v38 offset:0
    v_cvt_pk_f16_f32 v39, v150, v151
    ds_write_b32 v18, v39 offset:272
    v_cvt_pk_f16_f32 v40, v152, v153
    ds_write_b32 v18, v40 offset:544
    v_cvt_pk_f16_f32 v41, v154, v155
    ds_write_b32 v18, v41 offset:816
    v_pk_mul_f32 v[34:35], v[148:149], v[32:33] op_sel:[0,0] op_sel_hi:[1,0]
    v_pk_fma_f32 v[148:149], v[148:149], v[32:33], v[34:35] op_sel:[1,1,0] op_sel_hi:[0,1,1] neg_lo:[0,1,0]
    v_pk_mul_f32 v[42:43], v[152:153], v[32:33] op_sel:[0,0] op_sel_hi:[1,0]
    v_pk_fma_f32 v[152:153], v[152:153], v[32:33], v[42:43] op_sel:[1,1,0] op_sel_hi:[0,1,1] neg_lo:[0,1,0]
    v_cvt_pk_f16_f32 v38, v148, v149
    ds_write_b32 v18, v38 offset:1088
    v_cvt_pk_f16_f32 v39, v152, v153
    ds_write_b32 v18, v39 offset:1360
    v_pk_mul_f32 v[34:35], v[148:149], v[32:33] op_sel:[0,0] op_sel_hi:[1,0]
    v_pk_fma_f32 v[148:149], v[148:149], v[32:33], v[34:35] op_sel:[1,1,0] op_sel_hi:[0,1,1] neg_lo:[0,1,0]
    v_pk_mul_f32 v[42:43], v[152:153], v[32:33] op_sel:[0,0] op_sel_hi:[1,0]
    v_pk_fma_f32 v[152:153], v[152:153], v[32:33], v[42:43] op_sel:[1,1,0] op_sel_hi:[0,1,1] neg_lo:[0,1,0]
    v_cvt_pk_f16_f32 v40, v148, v149
    ds_write_b32 v18, v40 offset:1632
    v_cvt_pk_f16_f32 v41, v152, v153
    ds_write_b32 v18, v41 offset:1904
    v_pk_mul_f32 v[34:35], v[148:149], v[32:33] op_sel:[0,0] op_sel_hi:[1,0]
    v_pk_fma_f32 v[148:149], v[148:149], v[32:33], v[34:35] op_sel:[1,1,0] op_sel_hi:[0,1,1] neg_lo:[0,1,0]
    v_cvt_pk_f16_f32 v38, v148, v149
    ds_write_b32 v18, v38 offset:2176
    s_not_b64 exec, s[30:31]
    ds_read_b128 v[96:99], v19 offset:0
    ds_read_b128 v[100:103], v19 offset:32
    ds_read_b128 v[104:107], v19 offset:64
    ds_read_b128 v[108:111], v19 offset:96
    ds_read_b128 v[112:115], v19 offset:128
    ds_read_b128 v[116:119], v19 offset:160
    ds_read_b128 v[120:123], v19 offset:192
    ds_read_b128 v[124:127], v19 offset:224
    s_mov_b64 exec, -1
    v_add_u32 v20, s28, v2
    s_xor_b32 s26, s54, 1
    s_mul_i32 s26, s26, 4352
    s_add_u32 s26, s26, 141568
    v_add_u32 v21, s26, v2
    v_cmp_eq_u32 vcc, 0, v1
    s_cmp_eq_u32 s24, 0
    s_cselect_b64 s[26:27], vcc, 0
    v_cndmask_b32 v15, v6, v15, s[26:27]
    s_waitcnt lgkmcnt(7)
    v_mfma_f32_32x32x16_f16 v[48:63], v[64:67], v[96:99], 0
    s_waitcnt lgkmcnt(6)
    v_mfma_f32_32x32x16_f16 v[48:63], v[68:71], v[100:103], v[48:63]
    s_waitcnt lgkmcnt(5)
    v_mfma_f32_32x32x16_f16 v[48:63], v[72:75], v[104:107], v[48:63]
    s_waitcnt lgkmcnt(4)
    v_mfma_f32_32x32x16_f16 v[48:63], v[76:79], v[108:111], v[48:63]
    s_waitcnt lgkmcnt(3)
    v_mfma_f32_32x32x16_f16 v[48:63], v[80:83], v[112:115], v[48:63]
    s_waitcnt lgkmcnt(2)
    v_mfma_f32_32x32x16_f16 v[48:63], v[84:87], v[116:119], v[48:63]
    s_waitcnt lgkmcnt(1)
    v_mfma_f32_32x32x16_f16 v[48:63], v[88:91], v[120:123], v[48:63]
    s_waitcnt lgkmcnt(0)
    v_mfma_f32_32x32x16_f16 v[48:63], v[92:95], v[124:127], v[48:63]
    s_mul_i32 s28, s23, 8704
    s_add_u32 s28, s28, 141568
    s_lshl_b32 s26, s24, 11
    s_add_u32 s26, s26, s28
    v_add_u32 v22, s26, v2
    v_mov_b64 v[72:73], 0
    v_mov_b64 v[74:75], 0
    v_and_b32 v23, 3, v1
    v_lshlrev_b32 v23, 4, v23
    s_mul_i32 s26, s24, 4160
    s_add_u32 s26, s26, s28
    v_add_u32 v23, s26, v23
    ds_write_b128 v20, v[56:59]
    ds_write_b128 v20, v[60:63] offset:1024
    s_mov_b64 exec, 1
    ds_add_u32 v165, v167 offset:24
    s_mov_b64 exec, -1
    s_mov_b32 s35, 30000
SP_25:
    ds_read_b32 v164, v165 offset:24
    s_waitcnt lgkmcnt(0)
    v_readfirstlane_b32 s34, v164
    s_nop 0
    s_cmp_ge_u32 s34, 2
    s_cbranch_scc1 SD_26
    s_sleep 1
    s_sub_u32 s35, s35, 1
    s_cmp_lg_u32 s35, 0
    s_cbranch_scc1 SP_25
SD_26:
    ds_read_b128 v[56:59], v21
    ds_read_b128 v[60:63], v21 offset:1024
    s_waitcnt lgkmcnt(0)
    v_add_f32 v48, v48, v56
    v_add_f32 v49, v49, v57
    v_add_f32 v50, v50, v58
    v_add_f32 v51, v51, v59
    v_add_f32 v52, v52, v60
    v_add_f32 v53, v53, v61
    v_add_f32 v54, v54, v62
    v_add_f32 v55, v55, v63
    v_fma_f32 v48, v48, v24, v15
    v_mul_f32 v49, v49, v24
    v_mul_f32 v50, v50, v24
    v_mul_f32 v51, v51, v24
    v_mul_f32 v52, v52, v24
    v_mul_f32 v53, v53, v24
    v_mul_f32 v54, v54, v24
    v_mul_f32 v55, v55, v24
    v_cvt_pk_bf16_f32 v48, v48, v49
    ds_write_b16 v156, v48
    ds_write_b16_d16_hi v157, v48
    v_cvt_pk_bf16_f32 v50, v50, v51
    ds_write_b16 v158, v50
    ds_write_b16_d16_hi v159, v50
    v_cvt_pk_bf16_f32 v52, v52, v53
    ds_write_b16 v160, v52
    ds_write_b16_d16_hi v161, v52
    v_cvt_pk_bf16_f32 v54, v54, v55
    ds_write_b16 v162, v54
    ds_write_b16_d16_hi v163, v54
    s_mov_b64 exec, 1
    ds_add_u32 v165, v167 offset:28
    s_mov_b64 exec, -1
    s_mov_b32 s35, 30000
SP_27:
    ds_read_b32 v164, v165 offset:28
    s_waitcnt lgkmcnt(0)
    v_readfirstlane_b32 s34, v164
    s_nop 0
    s_cmp_ge_u32 s34, 2
    s_cbranch_scc1 SD_28
    s_sleep 1
    s_sub_u32 s35, s35, 1
    s_cmp_lg_u32 s35, 0
    s_cbranch_scc1 SP_27
SD_28:
    ds_read_u16 v128, v128
    ds_read_u16 v129, v129
    ds_read_u16 v130, v130
    ds_read_u16 v131, v131
    ds_read_u16 v132, v132
    ds_read_u16 v133, v133
    ds_read_u16 v134, v134
    ds_read_u16 v135, v135
    ds_read_u16 v136, v136
    ds_read_u16 v137, v137
    ds_read_u16 v138, v138
    ds_read_u16 v139, v139
    ds_read_u16 v140, v140
    ds_read_u16 v141, v141
    ds_read_u16 v142, v142
    ds_read_u16 v143, v143
    ds_read_u16 v144, v144
    ds_read_u16 v145, v145
    ds_write_b128 v23, v[72:75] offset:4096
    s_waitcnt lgkmcnt(1)
    v_lshl_or_b32 v76, v129, 16, v128
    v_lshl_or_b32 v77, v131, 16, v130
    v_lshl_or_b32 v78, v133, 16, v132
    v_lshl_or_b32 v79, v135, 16, v134
    ds_write_b128 v22, v[76:79] offset:0
    v_lshl_or_b32 v80, v130, 16, v129
    v_lshl_or_b32 v81, v132, 16, v131
    v_lshl_or_b32 v82, v134, 16, v133
    v_lshl_or_b32 v83, v136, 16, v135
    ds_write_b128 v22, v[80:83] offset:4160
    v_lshl_or_b32 v84, v138, 16, v137
    v_lshl_or_b32 v85, v140, 16, v139
    v_lshl_or_b32 v86, v142, 16, v141
    v_lshl_or_b32 v87, v144, 16, v143
    ds_write_b128 v22, v[84:87] offset:1024
    v_lshl_or_b32 v88, v139, 16, v138
    v_lshl_or_b32 v89, v141, 16, v140
    v_lshl_or_b32 v90, v143, 16, v142
    v_lshl_or_b32 v91, v145, 16, v144
    ds_write_b128 v22, v[88:91] offset:5184
    s_mov_b64 exec, 1
    ds_add_u32 v166, v167 offset:32
    s_mov_b64 exec, -1
    s_branch M_att
F_help:
    s_setprio 3
    v_lshrrev_b32 v3, 3, v1
    v_lshlrev_b32 v3, 10, v3
    v_and_b32 v4, 7, v1
    v_lshrrev_b32 v5, 4, v1
    v_xor_b32 v10, v4, v5
    v_xor_b32 v11, 4, v10
    v_lshl_add_u32 v10, v10, 4, v3
    v_lshl_add_u32 v11, v11, 4, v3
    v_add_u32 v11, 0x2000, v11
    v_and_b32 v7, 1, v5
    v_lshlrev_b32 v7, 1, v7
    v_xor_b32 v7, v4, v7
    v_lshl_add_u32 v12, v7, 4, v3
    v_xor_b32 v7, 4, v7
    v_lshl_add_u32 v13, v7, 4, v3
    v_add_u32 v13, 0x2000, v13
    s_memrealtime s[72:73]
    v_mov_b32 v6, 0
    s_and_b32 s30, s22, 1
    s_lshr_b32 s31, s22, 1
    s_lshl_b32 s26, s21, 16
    s_lshl_b32 s27, s31, 14
    s_add_u32 s27, s26, s27
    s_lshl_b32 s28, s24, 8
    s_add_u32 s27, s27, s28
    s_lshl_b32 s28, s24, 14
    s_add_u32 s26, s26, s28
    s_lshl_b32 s29, s31, 11
    s_add_u32 s29, s29, s28
    s_lshl_b32 s23, s22, 7
    s_add_u32 s23, s23, s28
    s_lshl_b32 s25, s24, 11
    s_lshl_b32 s28, s24, 12
    s_add_u32 s32, s28, 114688
    s_add_u32 s33, s2, s24
    s_waitcnt lgkmcnt(0)
    s_cmp_lg_u32 s33, 0
    s_cbranch_scc1 H_nn
    s_or_b32 s33, s72, 1
    v_mov_b32 v7, s33
    s_mov_b64 exec, 1
    global_store_dword v6, v7, s[48:49] sc1
    s_mov_b64 exec, -1
H_nn:
    s_mov_b32 s8, s36
    s_mov_b32 s9, s37
    s_mov_b32 s10, 2097152
    s_mov_b32 s11, 0x00020000
    s_cmp_eq_u32 s30, 0
    s_cselect_b32 s4, s40, s42
    s_cselect_b32 s5, s41, s43
    s_mov_b32 s6, 16384
    s_mov_b32 s7, 0x00020000
    s_add_u32 m0, s29, 0
    s_add_u32 s33, s27, 0
    buffer_load_dwordx4 v10, s[8:11], s33 offen lds
    s_add_u32 m0, s29, 1024
    s_nop 0
    buffer_load_dwordx4 v11, s[8:11], s33 offen lds
    s_add_u32 m0, s29, 8192
    s_add_u32 s33, s27, 128
    buffer_load_dwordx4 v10, s[8:11], s33 offen lds
    s_add_u32 m0, s29, 9216
    s_nop 0
    buffer_load_dwordx4 v11, s[8:11], s33 offen lds
    s_add_u32 m0, s32, 0
    s_add_u32 s33, s28, 0
    buffer_load_dwordx4 v2, s[4:7], s33 offen lds
    s_add_u32 m0, s32, 1024
    s_add_u32 s33, s28, 1024
    buffer_load_dwordx4 v2, s[4:7], s33 offen lds
    s_add_u32 m0, s32, 2048
    s_add_u32 s33, s28, 2048
    buffer_load_dwordx4 v2, s[4:7], s33 offen lds
    s_add_u32 m0, s32, 3072
    s_add_u32 s33, s28, 3072
    buffer_load_dwordx4 v2, s[4:7], s33 offen lds
    s_mov_b32 s68, s44
    s_mov_b32 s69, s45
    s_mov_b32 s70, 1024
    s_mov_b32 s71, 0x00020000
    s_mov_b32 s12, s38
    s_mov_b32 s13, s39
    s_mov_b32 s14, 524288
    s_mov_b32 s15, 0x00020000
    s_mov_b32 s16, s50
    s_mov_b32 s17, s51
    s_mov_b32 s18, 16777216
    s_mov_b32 s19, 0x00020000
    s_mov_b32 m0, 131328
    s_nop 0
    buffer_load_dwordx4 v2, s[68:71], 0 offen lds
    s_barrier
    s_cmp_eq_u32 s24, s31
    s_cbranch_scc1 H_fin
    s_add_u32 m0, s25, 0
    s_add_u32 s28, s26, 0
    buffer_load_dwordx4 v10, s[8:11], s28 offen lds
    s_add_u32 m0, s25, 1024
    s_nop 0
    buffer_load_dwordx4 v11, s[8:11], s28 offen lds
    s_add_u32 m0, s25, 65536
    s_add_u32 s28, s23, 0
    buffer_load_dwordx4 v12, s[12:15], s28 offen lds
    s_add_u32 m0, s25, 66560
    s_nop 0
    buffer_load_dwordx4 v13, s[12:15], s28 offen lds
    s_add_u32 m0, s25, 8192
    s_add_u32 s28, s26, 128
    buffer_load_dwordx4 v10, s[8:11], s28 offen lds
    s_add_u32 m0, s25, 9216
    s_nop 0
    buffer_load_dwordx4 v11, s[8:11], s28 offen lds
    s_add_u32 m0, s25, 73728
    s_add_u32 s28, s23, 65536
    buffer_load_dwordx4 v12, s[12:15], s28 offen lds
    s_add_u32 m0, s25, 74752
    s_nop 0
    buffer_load_dwordx4 v13, s[12:15], s28 offen lds
    s_add_u32 m0, s25, 16384
    s_add_u32 s28, s26, 256
    buffer_load_dwordx4 v10, s[8:11], s28 offen lds
    s_add_u32 m0, s25, 17408
    s_nop 0
    buffer_load_dwordx4 v11, s[8:11], s28 offen lds
    s_add_u32 m0, s25, 81920
    s_add_u32 s28, s23, 131072
    buffer_load_dwordx4 v12, s[12:15], s28 offen lds
    s_add_u32 m0, s25, 82944
    s_nop 0
    buffer_load_dwordx4 v13, s[12:15], s28 offen lds
    v_and_b32 v3, 15, v1
    v_lshrrev_b32 v4, 1, v3
    v_xor_b32 v4, v4, v5
    v_lshlrev_b32 v7, 7, v3
    v_add_u32 v7, s29, v7
    v_lshl_add_u32 v14, v4, 4, v7
    v_xor_b32 v4, 4, v4
    v_lshl_add_u32 v15, v4, 4, v7
    v_bfe_u32 v7, v1, 2, 2
    v_lshl_add_u32 v7, v5, 3, v7
    v_lshlrev_b32 v16, 5, v7
    v_and_b32 v7, 3, v1
    v_and_b32 v4, 1, v1
    v_bfe_u32 v8, v1, 1, 1
    v_lshl_add_u32 v4, v4, 1, v8
    s_cmp_eq_u32 s30, 0
    s_cselect_b64 vcc, -1, 0
    v_cndmask_b32 v7, v4, v7, vcc
    v_lshl_add_u32 v16, v7, 3, v16
    v_add_u32 v16, s32, v16
    s_sub_u32 s28, s24, s31
    s_sub_u32 s28, s28, 1
    s_and_b32 s28, s28, 3
    s_lshl_b32 s28, s28, 10
    s_add_u32 s28, s28, 132352
    v_add_u32 v17, s28, v2
    s_waitcnt vmcnt(12)
    s_mov_b64 exec, 1
    ds_add_u32 v166, v167 offset:0
    s_mov_b64 exec, -1
    ds_read_b64_tr_b16 v[32:33], v16 offset:0
    ds_read_b64_tr_b16 v[34:35], v16 offset:128
    ds_read_b128 v[36:39], v14 offset:0
    ds_read_b64_tr_b16 v[40:41], v16 offset:1024
    ds_read_b64_tr_b16 v[42:43], v16 offset:1152
    ds_read_b128 v[44:47], v15 offset:0
    ds_read_b64_tr_b16 v[48:49], v16 offset:2048
    ds_read_b64_tr_b16 v[50:51], v16 offset:2176
    ds_read_b128 v[52:55], v14 offset:8192
    ds_read_b64_tr_b16 v[56:57], v16 offset:3072
    ds_read_b64_tr_b16 v[58:59], v16 offset:3200
    ds_read_b128 v[60:63], v15 offset:8192
    s_waitcnt lgkmcnt(0)
    s_cmp_eq_u32 s30, 0
    s_cbranch_scc0 H_kvva
    v_mfma_f32_16x16x32_bf16 v[28:31], v[32:35], v[36:39], 0
    v_mfma_f32_16x16x32_bf16 v[28:31], v[40:43], v[44:47], v[28:31]
    v_mfma_f32_16x16x32_bf16 v[28:31], v[48:51], v[52:55], v[28:31]
    v_mfma_f32_16x16x32_bf16 v[28:31], v[56:59], v[60:63], v[28:31]
    s_branch H_kvja
H_kvva:
    v_mfma_f32_16x16x32_bf16 v[28:31], v[36:39], v[32:35], 0
    v_mfma_f32_16x16x32_bf16 v[28:31], v[44:47], v[40:43], v[28:31]
    v_mfma_f32_16x16x32_bf16 v[28:31], v[52:55], v[48:51], v[28:31]
    v_mfma_f32_16x16x32_bf16 v[28:31], v[60:63], v[56:59], v[28:31]
H_kvja:
    s_nop 7
    ds_write_b128 v17, v[28:31]
    s_mov_b64 exec, 1
    ds_add_u32 v166, v167 offset:8
    s_mov_b64 exec, -1
    s_waitcnt vmcnt(8)
    s_add_u32 m0, s25, 24576
    s_add_u32 s28, s26, 384
    buffer_load_dwordx4 v10, s[8:11], s28 offen lds
    s_add_u32 m0, s25, 25600
    s_nop 0
    buffer_load_dwordx4 v11, s[8:11], s28 offen lds
    s_add_u32 m0, s25, 90112
    s_add_u32 s28, s23, 196608
    buffer_load_dwordx4 v12, s[12:15], s28 offen lds
    s_add_u32 m0, s25, 91136
    s_nop 0
    buffer_load_dwordx4 v13, s[12:15], s28 offen lds
    s_waitcnt vmcnt(8)
    s_add_u32 m0, s25, 32768
    s_add_u32 s28, s26, 512
    buffer_load_dwordx4 v10, s[8:11], s28 offen lds
    s_add_u32 m0, s25, 33792
    s_nop 0
    buffer_load_dwordx4 v11, s[8:11], s28 offen lds
    s_add_u32 m0, s25, 98304
    s_add_u32 s28, s23, 262144
    buffer_load_dwordx4 v12, s[12:15], s28 offen lds
    s_add_u32 m0, s25, 99328
    s_nop 0
    buffer_load_dwordx4 v13, s[12:15], s28 offen lds
    s_mov_b64 exec, 1
    ds_add_u32 v166, v167 offset:128
    s_mov_b64 exec, -1
    s_waitcnt vmcnt(8)
    s_add_u32 m0, s25, 40960
    s_add_u32 s28, s26, 640
    buffer_load_dwordx4 v10, s[8:11], s28 offen lds
    s_add_u32 m0, s25, 41984
    s_nop 0
    buffer_load_dwordx4 v11, s[8:11], s28 offen lds
    s_add_u32 m0, s25, 106496
    s_add_u32 s28, s23, 327680
    buffer_load_dwordx4 v12, s[12:15], s28 offen lds
    s_add_u32 m0, s25, 107520
    s_nop 0
    buffer_load_dwordx4 v13, s[12:15], s28 offen lds
    s_waitcnt vmcnt(8)
    s_add_u32 m0, s25, 49152
    s_add_u32 s28, s26, 768
    buffer_load_dwordx4 v10, s[8:11], s28 offen lds
    s_add_u32 m0, s25, 50176
    s_nop 0
    buffer_load_dwordx4 v11, s[8:11], s28 offen lds
    s_mov_b32 s35, 30000
SP_29:
    ds_read_b32 v164, v166 offset:8
    s_waitcnt lgkmcnt(0)
    v_readfirstlane_b32 s34, v164
    s_nop 0
    s_cmp_ge_u32 s34, 4
    s_cbranch_scc1 SD_30
    s_sleep 1
    s_sub_u32 s35, s35, 1
    s_cmp_lg_u32 s35, 0
    s_cbranch_scc1 SP_29
SD_30:
    s_add_u32 m0, s25, 114688
    s_add_u32 s28, s23, 393216
    buffer_load_dwordx4 v12, s[12:15], s28 offen lds
    s_add_u32 m0, s25, 115712
    s_nop 0
    buffer_load_dwordx4 v13, s[12:15], s28 offen lds
    s_mov_b64 exec, 1
    ds_add_u32 v166, v167 offset:132
    s_mov_b64 exec, -1
    s_waitcnt vmcnt(8)
    s_add_u32 m0, s25, 57344
    s_add_u32 s28, s26, 896
    buffer_load_dwordx4 v10, s[8:11], s28 offen lds
    s_add_u32 m0, s25, 58368
    s_nop 0
    buffer_load_dwordx4 v11, s[8:11], s28 offen lds
    s_add_u32 m0, s25, 122880
    s_add_u32 s28, s23, 458752
    buffer_load_dwordx4 v12, s[12:15], s28 offen lds
    s_add_u32 m0, s25, 123904
    s_nop 0
    buffer_load_dwordx4 v13, s[12:15], s28 offen lds
    s_waitcnt vmcnt(8)
    s_mov_b64 exec, 1
    ds_add_u32 v166, v167 offset:136
    s_mov_b64 exec, -1
    s_waitcnt vmcnt(4)
    s_waitcnt vmcnt(0)
    s_mov_b64 exec, 1
    ds_add_u32 v166, v167 offset:140
    s_mov_b64 exec, -1
    s_branch H_ldd
H_fin:
    s_add_u32 m0, s25, 65536
    s_add_u32 s28, s23, 0
    buffer_load_dwordx4 v12, s[12:15], s28 offen lds
    s_add_u32 m0, s25, 66560
    s_nop 0
    buffer_load_dwordx4 v13, s[12:15], s28 offen lds
    s_add_u32 m0, s25, 73728
    s_add_u32 s28, s23, 65536
    buffer_load_dwordx4 v12, s[12:15], s28 offen lds
    s_add_u32 m0, s25, 74752
    s_nop 0
    buffer_load_dwordx4 v13, s[12:15], s28 offen lds
    s_add_u32 m0, s25, 81920
    s_add_u32 s28, s23, 131072
    buffer_load_dwordx4 v12, s[12:15], s28 offen lds
    s_add_u32 m0, s25, 82944
    s_nop 0
    buffer_load_dwordx4 v13, s[12:15], s28 offen lds
    v_and_b32 v3, 15, v1
    v_lshrrev_b32 v4, 1, v3
    v_xor_b32 v4, v4, v5
    v_lshlrev_b32 v7, 7, v3
    v_add_u32 v7, s29, v7
    v_lshl_add_u32 v14, v4, 4, v7
    v_xor_b32 v4, 4, v4
    v_lshl_add_u32 v15, v4, 4, v7
    v_bfe_u32 v7, v1, 2, 2
    v_lshl_add_u32 v7, v5, 3, v7
    v_lshlrev_b32 v16, 5, v7
    v_and_b32 v7, 3, v1
    v_and_b32 v4, 1, v1
    v_bfe_u32 v8, v1, 1, 1
    v_lshl_add_u32 v4, v4, 1, v8
    s_cmp_eq_u32 s30, 0
    s_cselect_b64 vcc, -1, 0
    v_cndmask_b32 v7, v4, v7, vcc
    v_lshl_add_u32 v16, v7, 3, v16
    v_add_u32 v16, s32, v16
    s_lshl_b32 s33, s21, 1
    s_lshr_b32 s28, s31, 1
    s_add_u32 s33, s33, s28
    s_lshl_b32 s33, s33, 10
    s_lshl_b32 s28, s30, 16
    s_add_u32 s33, s33, s28
    s_and_b32 s28, s31, 1
    s_add_u32 s27, s30, 8
    s_lshl_b32 s28, s28, s27
    s_add_u32 s33, s33, s28
    s_sub_u32 s27, 9, s30
    v_lshrrev_b32 v18, 5, v1
    v_lshlrev_b32 v18, s27, v18
    v_lshl_add_u32 v18, v3, 4, v18
    v_add_u32 v17, 132352, v2
    s_mov_b32 s26, 0x0000ffff
    s_mov_b32 s27, 0x0000ffff
    s_waitcnt vmcnt(6)
    global_load_dword v19, v6, s[48:49] sc1
    s_mov_b64 exec, 1
    ds_add_u32 v166, v167 offset:0
    s_mov_b64 exec, -1
    ds_read_b64_tr_b16 v[32:33], v16 offset:0
    ds_read_b64_tr_b16 v[34:35], v16 offset:128
    ds_read_b128 v[36:39], v14 offset:0
    ds_read_b64_tr_b16 v[40:41], v16 offset:1024
    ds_read_b64_tr_b16 v[42:43], v16 offset:1152
    ds_read_b128 v[44:47], v15 offset:0
    ds_read_b64_tr_b16 v[48:49], v16 offset:2048
    ds_read_b64_tr_b16 v[50:51], v16 offset:2176
    ds_read_b128 v[52:55], v14 offset:8192
    ds_read_b64_tr_b16 v[56:57], v16 offset:3072
    ds_read_b64_tr_b16 v[58:59], v16 offset:3200
    ds_read_b128 v[60:63], v15 offset:8192
    s_waitcnt lgkmcnt(0)
    s_cmp_eq_u32 s30, 0
    s_cbranch_scc0 H_kvvb
    v_mfma_f32_16x16x32_bf16 v[28:31], v[32:35], v[36:39], 0
    v_mfma_f32_16x16x32_bf16 v[28:31], v[40:43], v[44:47], v[28:31]
    v_mfma_f32_16x16x32_bf16 v[28:31], v[48:51], v[52:55], v[28:31]
    v_mfma_f32_16x16x32_bf16 v[28:31], v[56:59], v[60:63], v[28:31]
    s_branch H_kvjb
H_kvvb:
    v_mfma_f32_16x16x32_bf16 v[28:31], v[36:39], v[32:35], 0
    v_mfma_f32_16x16x32_bf16 v[28:31], v[44:47], v[40:43], v[28:31]
    v_mfma_f32_16x16x32_bf16 v[28:31], v[52:55], v[48:51], v[28:31]
    v_mfma_f32_16x16x32_bf16 v[28:31], v[60:63], v[56:59], v[28:31]
H_kvjb:
    s_mov_b32 s35, 30000
SP_31:
    ds_read_b32 v164, v166 offset:8
    s_waitcnt lgkmcnt(0)
    v_readfirstlane_b32 s34, v164
    s_nop 0
    s_cmp_ge_u32 s34, 3
    s_cbranch_scc1 SD_32
    s_sleep 1
    s_sub_u32 s35, s35, 1
    s_cmp_lg_u32 s35, 0
    s_cbranch_scc1 SP_31
SD_32:
    ds_read_b128 v[32:35], v17
    ds_read_b128 v[36:39], v17 offset:1024
    ds_read_b128 v[40:43], v17 offset:2048
    s_waitcnt lgkmcnt(0)
    v_add_f32 v28, v28, v32
    v_add_f32 v36, v36, v40
    v_add_f32 v29, v29, v33
    v_add_f32 v37, v37, v41
    v_add_f32 v30, v30, v34
    v_add_f32 v38, v38, v42
    v_add_f32 v31, v31, v35
    v_add_f32 v39, v39, v43
    v_add_f32 v28, v28, v36
    v_add_f32 v29, v29, v37
    v_add_f32 v30, v30, v38
    v_add_f32 v31, v31, v39
    v_cvt_pk_bf16_f32 v28, v28, v29
    v_cvt_pk_bf16_f32 v29, v30, v31
    v_mov_b32 v30, v28
    v_mov_b32 v31, v29
    s_nop 0
    v_permlane16_swap_b32 v28, v30
    v_permlane16_swap_b32 v29, v31
    s_mov_b64 exec, s[26:27]
    buffer_store_dwordx4 v[28:31], v18, s[16:19], s33 offen sc1
    s_mov_b64 exec, -1
    s_mov_b64 exec, 1
    ds_add_u32 v166, v167 offset:8
    s_mov_b64 exec, -1
    s_waitcnt vmcnt(6)
    s_add_u32 m0, s25, 90112
    s_add_u32 s28, s23, 196608
    buffer_load_dwordx4 v12, s[12:15], s28 offen lds
    s_add_u32 m0, s25, 91136
    s_nop 0
    buffer_load_dwordx4 v13, s[12:15], s28 offen lds
    s_waitcnt vmcnt(6)
    s_add_u32 m0, s25, 98304
    s_add_u32 s28, s23, 262144
    buffer_load_dwordx4 v12, s[12:15], s28 offen lds
    s_add_u32 m0, s25, 99328
    s_nop 0
    buffer_load_dwordx4 v13, s[12:15], s28 offen lds
    s_mov_b64 exec, 1
    ds_add_u32 v166, v167 offset:128
    s_mov_b64 exec, -1
    s_waitcnt vmcnt(6)
    s_add_u32 m0, s25, 106496
    s_add_u32 s28, s23, 327680
    buffer_load_dwordx4 v12, s[12:15], s28 offen lds
    s_add_u32 m0, s25, 107520
    s_nop 0
    buffer_load_dwordx4 v13, s[12:15], s28 offen lds
    s_lshl_b32 s33, s2, 7
    s_add_u32 s33, s33, 196608
    s_mov_b32 s35, 30000
    s_waitcnt vmcnt(6)
H_np:
    v_cmp_eq_u32 vcc, 0, v19
    s_nop 0
    s_cbranch_vccz H_ng
    global_load_dword v19, v6, s[48:49] sc1
    s_waitcnt vmcnt(0)
    s_sub_u32 s35, s35, 1
    s_cmp_lg_u32 s35, 0
    s_cbranch_scc1 H_np
H_ng:
    s_mov_b64 exec, 1
    buffer_store_dword v19, v6, s[16:19], s33 offen sc1
    ds_write_b32 v166, v19 offset:12
    s_mov_b64 exec, -1
    s_waitcnt vmcnt(5)
    s_add_u32 m0, s25, 114688
    s_add_u32 s28, s23, 393216
    buffer_load_dwordx4 v12, s[12:15], s28 offen lds
    s_add_u32 m0, s25, 115712
    s_nop 0
    buffer_load_dwordx4 v13, s[12:15], s28 offen lds
    s_mov_b64 exec, 1
    ds_add_u32 v166, v167 offset:132
    s_mov_b64 exec, -1
    s_waitcnt vmcnt(5)
    s_add_u32 m0, s25, 122880
    s_add_u32 s28, s23, 458752
    buffer_load_dwordx4 v12, s[12:15], s28 offen lds
    s_add_u32 m0, s25, 123904
    s_nop 0
    buffer_load_dwordx4 v13, s[12:15], s28 offen lds
    s_waitcnt vmcnt(5)
    s_mov_b64 exec, 1
    ds_add_u32 v166, v167 offset:136
    s_mov_b64 exec, -1
    s_waitcnt vmcnt(2)
    s_waitcnt vmcnt(0)
    s_mov_b64 exec, 1
    ds_add_u32 v166, v167 offset:140
    s_mov_b64 exec, -1
H_ldd:
    v_bfe_u32 v3, v1, 2, 2
    v_lshl_add_u32 v4, v5, 3, v3
    v_bfe_u32 v7, v1, 1, 1
    s_lshl_b32 s26, s24, 1
    v_add_u32 v7, s26, v7
    v_lshrrev_b32 v8, 1, v4
    v_and_b32 v8, 7, v8
    v_xor_b32 v7, v7, v8
    v_lshlrev_b32 v8, 7, v4
    v_and_b32 v3, 1, v1
    v_lshl_add_u32 v8, v3, 3, v8
    s_lshl_b32 s26, s22, 13
    v_add_u32 v8, s26, v8
    v_lshl_add_u32 v10, v7, 4, v8
    v_xor_b32 v7, 2, v7
    v_lshl_add_u32 v11, v7, 4, v8
    s_lshl_b32 s26, s31, 2
    v_add_u32 v165, s26, v166
    s_mov_b32 s35, 30000
SP_33:
    ds_read_b32 v164, v166 offset:12
    s_waitcnt lgkmcnt(0)
    v_readfirstlane_b32 s33, v164
    s_nop 0
    s_cmp_ge_u32 s33, 1
    s_cbranch_scc1 SD_34
    s_sleep 1
    s_sub_u32 s35, s35, 1
    s_cmp_lg_u32 s35, 0
    s_cbranch_scc1 SP_33
SD_34:
    v_lshlrev_b32 v9, 7, v1
    s_lshl_b32 s27, s24, 13
    s_add_u32 s27, s27, 196608
    s_mov_b32 s35, 30000
PL_35:
    buffer_load_dword v16, v9, s[16:19], s27 offen sc1
    s_waitcnt vmcnt(0)
    v_cmp_ne_u32 vcc, s33, v16
    s_nop 0
    s_cbranch_vccz PD_36
    s_sleep 1
    s_sub_u32 s35, s35, 1
    s_cmp_lg_u32 s35, 0
    s_cbranch_scc1 PL_35
PD_36:
    s_mov_b64 exec, 1
    ds_add_u32 v166, v167 offset:16
    s_mov_b64 exec, -1
    s_mov_b32 s35, 30000
SP_37:
    ds_read_b32 v164, v165 offset:128
    s_waitcnt lgkmcnt(0)
    v_readfirstlane_b32 s34, v164
    s_nop 0
    s_cmp_ge_u32 s34, 4
    s_cbranch_scc1 SD_38
    s_sleep 1
    s_sub_u32 s35, s35, 1
    s_cmp_lg_u32 s35, 0
    s_cbranch_scc1 SP_37
SD_38:
    ds_read_b64_tr_b16 v[16:17], v10 offset:0
    ds_read_b64_tr_b16 v[18:19], v11 offset:512
    ds_read_b64_tr_b16 v[20:21], v10 offset:4096
    ds_read_b64_tr_b16 v[22:23], v11 offset:4608
    s_lshl_b32 s26, s22, 5
    s_add_u32 s26, s26, s21
    s_lshl_b32 s27, s26, 13
    s_add_u32 s27, s27, s25
    s_add_u32 s27, s27, 5242880
    v_mov_b32 v64, s33
    s_waitcnt lgkmcnt(0)
    buffer_store_dwordx4 v[16:19], v2, s[16:19], s27 offen sc1
    buffer_store_dwordx4 v[20:23], v2, s[16:19], s27 offen offset:1024 sc1
    s_mov_b32 s12, s52
    s_mov_b32 s13, s53
    s_mov_b32 s14, 524288
    s_mov_b32 s15, 0x00020000
    s_lshr_b32 s23, s24, 1
    s_and_b32 s30, s24, 1
    s_lshl_b32 s28, s23, 6
    v_add_u32 v165, s28, v166
    v_and_b32 v65, 7, v1
    v_lshlrev_b32 v65, 7, v65
    v_lshlrev_b32 v66, 13, v5
    v_bfe_u32 v7, v1, 1, 3
    v_lshl_add_u32 v66, v7, 8, v66
    v_lshl_add_u32 v66, v3, 4, v66
    v_and_b32 v67, 3, v7
    v_lshl_add_u32 v67, v3, 2, v67
    v_mul_u32_u24 v67, 1536, v67
    v_lshl_add_u32 v67, v5, 5, v67
    v_lshrrev_b32 v8, 2, v7
    v_lshl_add_u32 v67, v8, 4, v67
    s_lshl_b32 s28, s24, 8
    s_add_u32 s28, s28, 512
    v_add_u32 v67, s28, v67
    v_and_b32 v8, 31, v1
    v_lshrrev_b32 v9, 5, v1
    v_mul_u32_u24 v68, 1536, v9
    v_lshl_add_u32 v68, v8, 4, v68
    s_mul_i32 s28, s24, 3072
    s_add_u32 s28, s28, 0
    v_add_u32 v68, s28, v68
    v_and_b32 v10, 0x13, v8
    v_bfe_u32 v11, v8, 2, 1
    v_lshl_add_u32 v10, v11, 3, v10
    v_bfe_u32 v11, v8, 3, 1
    v_lshl_add_u32 v10, v11, 2, v10
    v_and_b32 v11, 1, v10
    v_xor_b32 v11, 1, v11
    v_mul_u32_u24 v69, 4160, v11
    v_and_b32 v10, 30, v10
    v_lshlrev_b32 v10, 1, v10
    v_sub_u32 v69, v69, v10
    v_lshl_add_u32 v69, v9, 4, v69
    s_mul_i32 s28, s23, 8704
    s_lshl_b32 s29, s30, 5
    s_add_u32 s29, s29, s28
    s_add_u32 s29, s29, 145468
    v_add_u32 v69, s29, v69
    s_mul_i32 s28, s30, 128
    s_add_u32 s28, s28, 4294963968
    v_add_u32 v70, s28, v69
    v_and_b32 v11, 1, v8
    v_xor_b32 v11, 1, v11
    v_mul_u32_u24 v79, 4160, v11
    v_and_b32 v11, 30, v8
    v_lshlrev_b32 v11, 1, v11
    v_sub_u32 v79, v79, v11
    v_lshl_add_u32 v79, v9, 4, v79
    s_mul_i32 s28, s23, 8704
    s_lshl_b32 s29, s30, 7
    s_add_u32 s28, s28, s29
    s_add_u32 s28, s28, 141628
    v_add_u32 v79, s28, v79
    v_and_b32 v10, 0x13, v8
    v_bfe_u32 v11, v8, 2, 1
    v_lshl_add_u32 v10, v11, 3, v10
    v_bfe_u32 v11, v8, 3, 1
    v_lshl_add_u32 v10, v11, 2, v10
    v_subrev_u32 v11, s30, v9
    v_add_u32 v81, 2, v11
    v_mul_u32_u24 v81, 1536, v81
    v_lshl_add_u32 v81, v10, 4, v81
    v_and_b32 v80, 3, v11
    v_mul_u32_u24 v80, 1536, v80
    v_ashrrev_i32 v11, 2, v11
    v_add_u32 v10, v10, v11
    v_lshl_add_u32 v80, v10, 4, v80
    s_mul_i32 s28, s23, 6144
    s_add_u32 s28, s28, 496
    v_add_u32 v80, s28, v80
    v_add_u32 v81, s28, v81
    v_add_u32 v71, 464, v68
    s_lshl_b32 s29, s24, 12
    s_add_u32 s29, s29, 12288
    v_add_u32 v14, s29, v2
    s_xor_b32 s29, s24, 1
    s_lshl_b32 s29, s29, 12
    s_add_u32 s29, s29, 12288
    v_add_u32 v15, s29, v2
    v_lshrrev_b32 v10, 3, v1
    v_lshlrev_b32 v76, 12, v10
    v_bfe_u32 v11, v1, 1, 2
    v_lshl_add_u32 v76, v11, 9, v76
    v_lshl_add_u32 v76, v3, 4, v76
    v_lshl_add_u32 v11, v3, 2, v11
    v_and_b32 v7, 2, v10
    v_xor_b32 v11, v11, v7
    v_lshlrev_b32 v10, 7, v10
    s_add_u32 s28, s25, 141568
    v_add_u32 v10, s28, v10
    v_lshl_add_u32 v77, v11, 4, v10
    v_xor_b32 v11, 4, v11
    v_lshl_add_u32 v78, v11, 4, v10
    v_mov_b64 v[72:73], 0
    v_mov_b64 v[74:75], 0
    v_mov_b64 v[32:33], 0
    v_mov_b64 v[34:35], 0
    v_mov_b64 v[36:37], 0
    v_mov_b64 v[38:39], 0
    v_mov_b64 v[40:41], 0
    v_mov_b64 v[42:43], 0
    v_mov_b64 v[44:45], 0
    v_mov_b64 v[46:47], 0
    v_mov_b64 v[48:49], 0
    v_mov_b64 v[50:51], 0
    v_mov_b64 v[52:53], 0
    v_mov_b64 v[54:55], 0
    v_mov_b64 v[56:57], 0
    v_mov_b64 v[58:59], 0
    v_mov_b64 v[60:61], 0
    v_mov_b64 v[62:63], 0
    s_waitcnt vmcnt(0)
    s_mov_b64 exec, 1
    ds_add_rtn_u32 v4, v166, v167 offset:20
    s_mov_b64 exec, -1
    s_waitcnt lgkmcnt(0)
    v_readfirstlane_b32 s27, v4
    s_nop 0
    s_cmp_lg_u32 s27, 3
    s_cbranch_scc1 H_noxp
    s_lshl_b32 s27, s26, 7
    s_add_u32 s27, s27, 458752
    s_mov_b64 exec, 1
    buffer_store_dword v64, v6, s[16:19], s27 offen sc1
    s_mov_b64 exec, -1
H_noxp:
    s_lshr_b32 s26, s2, 5
    s_lshl_b32 s27, s26, 12
    s_lshl_b32 s29, s24, 10
    s_add_u32 s27, s27, s29
    s_add_u32 s27, s27, 458752
    s_mov_b32 s35, 30000
PL_39:
    buffer_load_dword v7, v65, s[16:19], s27 offen sc1
    s_waitcnt vmcnt(0)
    v_cmp_ne_u32 vcc, s33, v7
    s_nop 0
    s_cbranch_vccz PD_40
    s_sleep 4
    s_sub_u32 s35, s35, 1
    s_cmp_lg_u32 s35, 0
    s_cbranch_scc1 PL_39
PD_40:
    s_lshl_b32 s26, s26, 18
    s_lshl_b32 s27, s24, 16
    s_add_u32 s26, s26, s27
    s_bfe_u32 s27, s2, 0x20003
    s_lshl_b32 s27, s27, 11
    s_add_u32 s26, s26, s27
    s_and_b32 s27, s2, 7
    s_lshl_b32 s27, s27, 5
    s_add_u32 s26, s26, s27
    s_add_u32 s26, s26, 5242880
    s_add_u32 s27, s26, 0x8000
    buffer_load_dwordx4 v[16:19], v66, s[16:19], s26 offen sc1
    buffer_load_dwordx4 v[20:23], v66, s[16:19], s27 offen sc1
    s_mov_b32 s35, 30000
SP_41:
    ds_read_b32 v164, v166 offset:4
    s_waitcnt lgkmcnt(0)
    v_readfirstlane_b32 s34, v164
    s_nop 0
    s_cmp_ge_u32 s34, 4
    s_cbranch_scc1 SD_42
    s_sleep 1
    s_sub_u32 s35, s35, 1
    s_cmp_lg_u32 s35, 0
    s_cbranch_scc1 SP_41
SD_42:
    s_mov_b32 s35, 30000
SP_43:
    ds_read_b32 v164, v166 offset:20
    s_waitcnt lgkmcnt(0)
    v_readfirstlane_b32 s34, v164
    s_nop 0
    s_cmp_ge_u32 s34, 4
    s_cbranch_scc1 SD_44
    s_sleep 1
    s_sub_u32 s35, s35, 1
    s_cmp_lg_u32 s35, 0
    s_cbranch_scc1 SP_43
SD_44:
    ds_write_b128 v68, v[72:75]
    s_waitcnt vmcnt(0)
    ds_write_b128 v67, v[16:19]
    ds_write_b128 v67, v[20:23] offset:128
    s_mov_b64 exec, 1
    ds_add_u32 v166, v167 offset:32
    s_mov_b64 exec, -1
    s_lshl_b32 s26, s24, 17
    s_lshl_b32 s27, s22, 7
    s_add_u32 s26, s26, s27
    s_lshl_b32 s27, s24, 14
    s_add_u32 s27, s27, 65536
    s_mov_b32 s29, 0
    s_mov_b32 s35, 30000
SP_45:
    ds_read_b32 v164, v166 offset:32
    s_waitcnt lgkmcnt(0)
    v_readfirstlane_b32 s34, v164
    s_nop 0
    s_cmp_ge_u32 s34, 8
    s_cbranch_scc1 SD_46
    s_sleep 1
    s_sub_u32 s35, s35, 1
    s_cmp_lg_u32 s35, 0
    s_cbranch_scc1 SP_45
SD_46:
H_cloop:
    s_mov_b32 m0, s27
    s_add_u32 s29, s29, 1
    buffer_load_dwordx4 v12, s[12:15], s26 offen lds
    s_add_u32 m0, s27, 1024
    s_add_u32 s27, s27, 2048
    buffer_load_dwordx4 v13, s[12:15], s26 offen lds
    s_add_u32 s26, s26, 16384
    ds_read2_b32 v[16:17], v69 offset0:48 offset1:49
    ds_read2_b32 v[18:19], v69 offset0:50 offset1:51
    ds_read_b128 v[24:27], v71 offset:48
    s_waitcnt lgkmcnt(0)
    v_mfma_f32_32x32x16_bf16 v[32:47], v[16:19], v[24:27], v[32:47]
    ds_read_b128 v[28:31], v71 offset:560
    s_waitcnt lgkmcnt(0)
    v_mfma_f32_32x32x16_bf16 v[48:63], v[16:19], v[28:31], v[48:63]
    ds_read2_b32 v[16:17], v69 offset0:32 offset1:33
    ds_read2_b32 v[18:19], v69 offset0:34 offset1:35
    ds_read_b128 v[24:27], v71 offset:32
    s_waitcnt lgkmcnt(0)
    v_mfma_f32_32x32x16_bf16 v[32:47], v[16:19], v[24:27], v[32:47]
    ds_read_b128 v[28:31], v71 offset:544
    s_waitcnt lgkmcnt(0)
    v_mfma_f32_32x32x16_bf16 v[48:63], v[16:19], v[28:31], v[48:63]
    ds_read2_b32 v[16:17], v69 offset0:16 offset1:17
    ds_read2_b32 v[18:19], v69 offset0:18 offset1:19
    ds_read_b128 v[24:27], v71 offset:16
    s_waitcnt lgkmcnt(0)
    v_mfma_f32_32x32x16_bf16 v[32:47], v[16:19], v[24:27], v[32:47]
    ds_read_b128 v[28:31], v71 offset:528
    s_waitcnt lgkmcnt(0)
    v_mfma_f32_32x32x16_bf16 v[48:63], v[16:19], v[28:31], v[48:63]
    ds_read2_b32 v[16:17], v69 offset0:0 offset1:1
    ds_read2_b32 v[18:19], v69 offset0:2 offset1:3
    ds_read_b128 v[24:27], v71 offset:0
    s_waitcnt lgkmcnt(0)
    v_mfma_f32_32x32x16_bf16 v[32:47], v[16:19], v[24:27], v[32:47]
    ds_read_b128 v[28:31], v71 offset:512
    v_subrev_u32 v69, 256, v69
    v_subrev_u32 v71, 64, v71
    s_waitcnt lgkmcnt(0)
    v_mfma_f32_32x32x16_bf16 v[48:63], v[16:19], v[28:31], v[48:63]
    s_cmp_lt_u32 s29, 8
    s_cbranch_scc1 H_cloop
    ds_read2_b32 v[16:17], v69 offset0:48 offset1:49
    ds_read2_b32 v[18:19], v69 offset0:50 offset1:51
    ds_read_b128 v[28:31], v71 offset:560
    s_waitcnt lgkmcnt(0)
    v_mfma_f32_32x32x16_bf16 v[48:63], v[16:19], v[28:31], v[48:63]
    ds_read2_b32 v[16:17], v69 offset0:32 offset1:33
    ds_read2_b32 v[18:19], v69 offset0:34 offset1:35
    ds_read_b128 v[28:31], v71 offset:544
    s_waitcnt lgkmcnt(0)
    v_mfma_f32_32x32x16_bf16 v[48:63], v[16:19], v[28:31], v[48:63]
    ds_read_b128 v[84:87], v80 offset:0
    ds_read_b128 v[88:91], v81 offset:0
    ds_read_b128 v[92:95], v80 offset:16
    ds_read_b128 v[96:99], v81 offset:16
    ds_read2_b32 v[100:101], v70 offset0:0 offset1:1
    ds_read2_b32 v[102:103], v70 offset0:2 offset1:3
    ds_read2_b32 v[104:105], v70 offset0:8 offset1:9
    ds_read2_b32 v[106:107], v70 offset0:10 offset1:11
    ds_read2_b32 v[108:109], v70 offset0:16 offset1:17
    ds_read2_b32 v[110:111], v70 offset0:18 offset1:19
    ds_read2_b32 v[128:129], v79 offset0:0 offset1:1
    ds_read2_b32 v[130:131], v79 offset0:2 offset1:3
    ds_read2_b32 v[132:133], v79 offset0:8 offset1:9
    ds_read2_b32 v[134:135], v79 offset0:10 offset1:11
    s_waitcnt lgkmcnt(0)
    v_mfma_f32_32x32x16_bf16 v[112:127], v[88:91], v[100:103], 0
    v_mfma_f32_32x32x16_bf16 v[112:127], v[92:95], v[104:107], v[112:127]
    v_mfma_f32_32x32x16_bf16 v[112:127], v[96:99], v[108:111], v[112:127]
    s_nop 11
    v_cvt_pk_bf16_f32 v16, v112, v113
    v_cvt_pk_bf16_f32 v17, v114, v115
    v_cvt_pk_bf16_f32 v18, v116, v117
    v_cvt_pk_bf16_f32 v19, v118, v119
    v_cvt_pk_bf16_f32 v20, v120, v121
    v_cvt_pk_bf16_f32 v21, v122, v123
    v_cvt_pk_bf16_f32 v22, v124, v125
    v_cvt_pk_bf16_f32 v23, v126, v127
    v_mfma_f32_32x32x16_bf16 v[48:63], v[16:19], v[128:131], v[48:63]
    s_nop 0
    v_mfma_f32_32x32x16_bf16 v[48:63], v[20:23], v[132:135], v[48:63]
    ds_read2_b32 v[128:129], v79 offset0:64 offset1:65
    ds_read2_b32 v[130:131], v79 offset0:66 offset1:67
    ds_read2_b32 v[132:133], v79 offset0:72 offset1:73
    ds_read2_b32 v[134:135], v79 offset0:74 offset1:75
    s_waitcnt lgkmcnt(0)
    v_mfma_f32_32x32x16_bf16 v[112:127], v[84:87], v[100:103], 0
    v_mfma_f32_32x32x16_bf16 v[112:127], v[88:91], v[104:107], v[112:127]
    v_mfma_f32_32x32x16_bf16 v[112:127], v[92:95], v[108:111], v[112:127]
    s_nop 11
    v_cvt_pk_bf16_f32 v16, v112, v113
    v_cvt_pk_bf16_f32 v17, v114, v115
    v_cvt_pk_bf16_f32 v18, v116, v117
    v_cvt_pk_bf16_f32 v19, v118, v119
    v_cvt_pk_bf16_f32 v20, v120, v121
    v_cvt_pk_bf16_f32 v21, v122, v123
    v_cvt_pk_bf16_f32 v22, v124, v125
    v_cvt_pk_bf16_f32 v23, v126, v127
    v_mfma_f32_32x32x16_bf16 v[48:63], v[16:19], v[128:131], v[48:63]
    s_nop 0
    v_mfma_f32_32x32x16_bf16 v[48:63], v[20:23], v[132:135], v[48:63]
    s_lshl_b32 s27, s2, 13
    s_lshl_b32 s29, s24, 11
    s_add_u32 s27, s27, s29
    s_add_u32 s27, s27, 3145728
    s_cmp_eq_u32 s30, 1
    s_cbranch_scc1 H_cv1
    s_nop 5
    ds_write_b128 v14, v[48:51] offset:0
    ds_write_b128 v14, v[52:55] offset:1024
    ds_write_b128 v14, v[56:59] offset:2048
    ds_write_b128 v14, v[60:63] offset:3072
    s_mov_b64 exec, 1
    ds_add_u32 v165, v167 offset:36
    s_mov_b64 exec, -1
    s_mov_b32 s35, 30000
SP_47:
    ds_read_b32 v164, v165 offset:36
    s_waitcnt lgkmcnt(0)
    v_readfirstlane_b32 s34, v164
    s_nop 0
    s_cmp_ge_u32 s34, 2
    s_cbranch_scc1 SD_48
    s_sleep 1
    s_sub_u32 s35, s35, 1
    s_cmp_lg_u32 s35, 0
    s_cbranch_scc1 SP_47
SD_48:
    ds_read_b128 v[48:51], v15 offset:0
    ds_read_b128 v[52:55], v15 offset:1024
    ds_read_b128 v[56:59], v15 offset:2048
    ds_read_b128 v[60:63], v15 offset:3072
    s_waitcnt lgkmcnt(0)
    v_pk_add_f32 v[32:33], v[32:33], v[48:49]
    v_pk_add_f32 v[34:35], v[34:35], v[50:51]
    v_pk_add_f32 v[36:37], v[36:37], v[52:53]
    v_pk_add_f32 v[38:39], v[38:39], v[54:55]
    v_pk_add_f32 v[40:41], v[40:41], v[56:57]
    v_pk_add_f32 v[42:43], v[42:43], v[58:59]
    v_pk_add_f32 v[44:45], v[44:45], v[60:61]
    v_pk_add_f32 v[46:47], v[46:47], v[62:63]
    v_cvt_pk_bf16_f32 v16, v32, v33
    v_cvt_pk_bf16_f32 v17, v34, v35
    v_cvt_pk_bf16_f32 v18, v36, v37
    v_cvt_pk_bf16_f32 v19, v38, v39
    v_cvt_pk_bf16_f32 v20, v40, v41
    v_cvt_pk_bf16_f32 v21, v42, v43
    v_cvt_pk_bf16_f32 v22, v44, v45
    v_cvt_pk_bf16_f32 v23, v46, v47
    s_branch H_cvj
H_cv1:
    ds_write_b128 v14, v[32:35] offset:0
    ds_write_b128 v14, v[36:39] offset:1024
    ds_write_b128 v14, v[40:43] offset:2048
    ds_write_b128 v14, v[44:47] offset:3072
    s_mov_b64 exec, 1
    ds_add_u32 v165, v167 offset:36
    s_mov_b64 exec, -1
    s_mov_b32 s35, 30000
SP_49:
    ds_read_b32 v164, v165 offset:36
    s_waitcnt lgkmcnt(0)
    v_readfirstlane_b32 s34, v164
    s_nop 0
    s_cmp_ge_u32 s34, 2
    s_cbranch_scc1 SD_50
    s_sleep 1
    s_sub_u32 s35, s35, 1
    s_cmp_lg_u32 s35, 0
    s_cbranch_scc1 SP_49
SD_50:
    ds_read_b128 v[32:35], v15 offset:0
    ds_read_b128 v[36:39], v15 offset:1024
    ds_read_b128 v[40:43], v15 offset:2048
    ds_read_b128 v[44:47], v15 offset:3072
    s_waitcnt lgkmcnt(0)
    v_pk_add_f32 v[48:49], v[48:49], v[32:33]
    v_pk_add_f32 v[50:51], v[50:51], v[34:35]
    v_pk_add_f32 v[52:53], v[52:53], v[36:37]
    v_pk_add_f32 v[54:55], v[54:55], v[38:39]
    v_pk_add_f32 v[56:57], v[56:57], v[40:41]
    v_pk_add_f32 v[58:59], v[58:59], v[42:43]
    v_pk_add_f32 v[60:61], v[60:61], v[44:45]
    v_pk_add_f32 v[62:63], v[62:63], v[46:47]
    v_cvt_pk_bf16_f32 v16, v48, v49
    v_cvt_pk_bf16_f32 v17, v50, v51
    v_cvt_pk_bf16_f32 v18, v52, v53
    v_cvt_pk_bf16_f32 v19, v54, v55
    v_cvt_pk_bf16_f32 v20, v56, v57
    v_cvt_pk_bf16_f32 v21, v58, v59
    v_cvt_pk_bf16_f32 v22, v60, v61
    v_cvt_pk_bf16_f32 v23, v62, v63
H_cvj:
    buffer_store_dwordx4 v[16:19], v2, s[16:19], s27 offen sc1
    buffer_store_dwordx4 v[20:23], v2, s[16:19], s27 offen offset:1024 sc1
    s_waitcnt vmcnt(0)
    s_mov_b64 exec, 1
    ds_add_rtn_u32 v4, v166, v167 offset:40
    s_mov_b64 exec, -1
    s_waitcnt lgkmcnt(0)
    v_readfirstlane_b32 s27, v4
    s_nop 0
    s_cmp_lg_u32 s27, 3
    s_cbranch_scc1 H_nopub
    s_lshl_b32 s27, s2, 7
    s_add_u32 s27, s27, 262144
    s_mov_b64 exec, 1
    buffer_store_dword v64, v6, s[16:19], s27 offen sc1
    s_mov_b64 exec, -1
H_nopub:
    s_lshl_b32 s27, s22, 12
    s_lshl_b32 s29, s24, 10
    s_add_u32 s27, s27, s29
    s_add_u32 s27, s27, 262144
    s_mov_b32 s35, 30000
PL_51:
    buffer_load_dword v7, v65, s[16:19], s27 offen sc1
    s_waitcnt vmcnt(0)
    v_cmp_ne_u32 vcc, s33, v7
    s_nop 0
    s_cbranch_vccz PD_52
    s_sleep 8
    s_sub_u32 s35, s35, 1
    s_cmp_lg_u32 s35, 0
    s_cbranch_scc1 PL_51
PD_52:
    s_lshl_b32 s27, s22, 18
    s_lshl_b32 s29, s24, 16
    s_add_u32 s27, s27, s29
    s_lshr_b32 s29, s21, 4
    s_lshl_b32 s29, s29, 11
    s_add_u32 s27, s27, s29
    s_and_b32 s29, s21, 15
    s_lshl_b32 s29, s29, 5
    s_add_u32 s27, s27, s29
    s_add_u32 s27, s27, 3145728
    s_add_u32 s29, s27, 0x8000
    buffer_load_dwordx4 v[24:27], v76, s[16:19], s27 offen sc1
    buffer_load_dwordx4 v[28:31], v76, s[16:19], s29 offen sc1
    s_mov_b32 s35, 30000
SP_53:
    ds_read_b32 v164, v166 offset:40
    s_waitcnt lgkmcnt(0)
    v_readfirstlane_b32 s34, v164
    s_nop 0
    s_cmp_ge_u32 s34, 4
    s_cbranch_scc1 SD_54
    s_sleep 1
    s_sub_u32 s35, s35, 1
    s_cmp_lg_u32 s35, 0
    s_cbranch_scc1 SP_53
SD_54:
    s_waitcnt vmcnt(0)
    ds_write_b128 v77, v[24:27]
    ds_write_b128 v78, v[28:31] offset:1024
    s_mov_b64 exec, 1
    ds_add_u32 v166, v167 offset:44
    s_mov_b64 exec, -1
    s_waitcnt lgkmcnt(0)
    s_endpgm
F_end:
    s_endpgm
.section .rodata,"a"
.p2align 6
.amdhsa_kernel gated_mix__grouped_kv_mqa__ssm_conv_s4d__prompt_kernel
  .amdhsa_next_free_vgpr 168
  .amdhsa_next_free_sgpr 102
  .amdhsa_accum_offset 168
  .amdhsa_group_segment_fixed_size 0
  .amdhsa_kernarg_size 128
  .amdhsa_user_sgpr_count 2
  .amdhsa_user_sgpr_kernarg_segment_ptr 1
  .amdhsa_system_sgpr_workgroup_id_x 1
.end_amdhsa_kernel
```
